```python
import torch

def _softmax(x, axis=-1):
    return torch.softmax(x, dim=axis)
def _gelu(x):
    return torch.nn.functional.gelu(x, approximate="tanh")
def _silu(x):
    return torch.nn.functional.silu(x)
def _sigmoid(x):
    return torch.sigmoid(x)
def _layernorm(x, axis=-1, eps=1e-5):
    m = x.mean(dim=axis, keepdim=True)
    v = x.var(dim=axis, keepdim=True, unbiased=False)
    return (x - m) / torch.sqrt(v + eps)
def _scatter_add(tgt, idx, src, axis=0):
    return tgt.clone().index_add_(axis, idx, src)
def _segment_sum(src, seg, n):
    out = torch.zeros((n,) + src.shape[1:], dtype=src.dtype)
    return out.index_add_(0, seg, src)
def _pad(x, pw):
    flat = tuple(v for pair in reversed(pw) for v in pair)
    return torch.nn.functional.pad(x, flat)

kernel_name = 'recurrent_scan__mha_block_cached__dense_activation_gelu__decode'

def setup_inputs():

    _w = (lambda a: (lambda t: t.to(torch.bfloat16) if t.is_floating_point() else t)(torch.as_tensor(a)))
    def _A_setup():
        B, Sq, D = 1, 1, 640
        H, Sk, Dh = 32, 32768, 192
        return {
            "x": _w((lambda *s: torch.randn(*s, dtype=torch.bfloat16) * 0.4)(B, Sq, D)),
            "k_cache": _w((lambda *s: torch.randn(*s, dtype=torch.bfloat16) * 1.6)(B, H, Sk, Dh)),
            "v_cache": _w((lambda *s: torch.randn(*s, dtype=torch.bfloat16) * 1.6)(B, H, Sk, Dh)),
            "wq": _w((lambda *s: torch.randn(*s, dtype=torch.bfloat16) * 1.6)(D, H * Dh) * (D ** -0.5)),
            "wo": _w((lambda *s: torch.randn(*s, dtype=torch.bfloat16) * 1.6)(H * Dh, D) * ((H * Dh) ** -0.5)),
        }
    _A_in = _A_setup()

    def _B_setup():
        B, S, D, F = 1, 1, 640, 1536
        return {
            "x": _w((lambda *s: torch.randn(*s, dtype=torch.bfloat16) * 0.4)(B, S, D)),
            "w1": _w((lambda *s: torch.randn(*s, dtype=torch.bfloat16) * 1.6)(D, F) * (D ** -0.5)),
            "b1": _w((lambda *s: torch.randn(*s, dtype=torch.bfloat16) * 1.6)(F) * 0.01),
            "w2": _w((lambda *s: torch.randn(*s, dtype=torch.bfloat16) * 1.6)(F, D) * (F ** -0.5)),
            "b2": _w((lambda *s: torch.randn(*s, dtype=torch.bfloat16) * 1.6)(D) * 0.01),
        }
    _B_in = _B_setup()

    return {
        "A_x": _A_in["x"],
        "A_k_cache": _A_in["k_cache"],
        "A_v_cache": _A_in["v_cache"],
        "A_wq": _A_in["wq"],
        "A_wo": _A_in["wo"],
        "B_x": _B_in["x"],
        "B_w1": _B_in["w1"],
        "B_b1": _B_in["b1"],
        "B_w2": _B_in["w2"],
        "B_b2": _B_in["b2"],
    }

def reference(A_x, A_k_cache, A_v_cache, A_wq, A_wo, B_x, B_w1, B_b1, B_w2, B_b2):
    def _A_ref(x, k_cache, v_cache, wq, wo):
        B, Sq, D = x.shape
        H, Dh = 32, 192
        q = (lambda x, *d: x.permute(*d))((x @ wq).reshape(B, Sq, H, Dh), 0, 2, 1, 3)
        scores = torch.einsum("bhqd,bhkd->bhqk", q, k_cache) * (Dh ** -0.5)
        p = _softmax(scores, axis=-1)
        o = torch.einsum("bhqk,bhkd->bhqd", p, v_cache)
        return (lambda x, *d: x.permute(*d))(o, 0, 2, 1, 3).reshape(B, Sq, H * Dh) @ wo

    def _B_ref(x, w1, b1, w2, b2):
        h = torch.einsum("bsd,df->bsf", x, w1) + b1
        h = _gelu(h)
        return torch.einsum("bsf,fd->bsd", h, w2) + b2

    x = A_x
    xn = _layernorm(x, axis=-1)
    s = _A_ref(xn, A_k_cache, A_v_cache, A_wq, A_wo)
    g = _silu(_B_ref(xn, B_w1, B_b1, B_w2, B_b2))
    return x + s * g
```

```asm
; @launch kernel=proj_kernel grid=(240,1,1) block=(512,1,1) lds=32768
; @launch kernel=attn_kernel grid=(256,1,1) block=(576,1,1) lds=12288
; @launch kernel=oproj_kernel grid=(256,1,1) block=(512,1,1) lds=81920
; @launch kernel=final_kernel grid=(20,1,1) block=(256,1,1) lds=4096
.amdgcn_target "amdgcn-amd-amdhsa--gfx950"
.text
.globl proj_kernel
.p2align 8
.type proj_kernel,@function
proj_kernel:
    s_cmp_ge_u32 s2, 240
    s_cbranch_scc1 P_done
    s_load_dwordx2 s[4:5], s[0:1], 0
    s_load_dwordx2 s[10:11], s[0:1], 24
    s_load_dwordx2 s[16:17], s[0:1], 48
    s_load_dwordx2 s[26:27], s[0:1], 96
    v_and_b32 v1, 63, v0
    v_lshrrev_b32 v2, 6, v0
    v_lshlrev_b32 v7, 2, v1
    v_readfirstlane_b32 s28, v2
    v_lshrrev_b32 v5, 4, v1
    v_and_b32 v6, 15, v1
    v_lshlrev_b32 v6, 4, v6
    s_cmp_ge_u32 s2, 192
    s_cselect_b32 s63, 3, 12
    s_cselect_b32 s61, 192, 0
    s_lshl_b32 s63, s63, 10
    s_sub_u32 s56, s2, s61
    s_and_b32 s30, s56, 3
    s_lshr_b32 s56, s56, 2
    s_lshl_b32 s56, s56, 8
    v_mul_lo_u32 v3, s63, v5
    v_add_u32 v3, v3, v6
    s_mul_i32 s31, s28, 20
    s_mul_i32 s59, s30, 160
    s_add_u32 s31, s31, s59
    s_mul_i32 s58, s31, s63
    s_add_u32 s62, s56, s58
    s_lshl_b32 s63, s63, 2
    s_waitcnt lgkmcnt(0)
    s_mov_b32 s48, s4
    s_mov_b32 s49, s5
    s_mov_b32 s50, 1280
    s_mov_b32 s51, 0x00020000
    buffer_load_dword v60, v7, s[48:51], 0 offen offset:0
    buffer_load_dword v61, v7, s[48:51], 0 offen offset:256
    buffer_load_dword v62, v7, s[48:51], 0 offen offset:512
    buffer_load_dword v63, v7, s[48:51], 0 offen offset:768
    buffer_load_dword v64, v7, s[48:51], 0 offen offset:1024
    s_cmp_ge_u32 s2, 192
    s_cbranch_scc1 P_w1
    s_mov_b32 s40, s10
    s_mov_b32 s41, s11
    s_mov_b32 s42, 7864320
    s_mov_b32 s43, 0x00020000
    s_mul_i32 s29, s30, 24576
    s_add_u32 s29, s29, 65536
    s_branch P_go
P_w1:
    s_mov_b32 s40, s16
    s_mov_b32 s41, s17
    s_mov_b32 s42, 1966080
    s_mov_b32 s43, 0x00020000
    s_mul_i32 s29, s30, 6144
    s_add_u32 s29, s29, 32768
P_go:
    buffer_load_dwordx4 v[8:11], v3, s[40:43], s62 offen nt
    s_add_u32 s62, s62, s63
    buffer_load_dwordx4 v[12:15], v3, s[40:43], s62 offen nt
    s_add_u32 s62, s62, s63
    buffer_load_dwordx4 v[16:19], v3, s[40:43], s62 offen nt
    s_add_u32 s62, s62, s63
    buffer_load_dwordx4 v[20:23], v3, s[40:43], s62 offen nt
    s_add_u32 s62, s62, s63
    buffer_load_dwordx4 v[24:27], v3, s[40:43], s62 offen nt
    s_add_u32 s62, s62, s63
    s_mov_b32 s52, s26
    s_mov_b32 s53, s27
    s_mov_b32 s54, 1540096
    s_mov_b32 s55, 0x00020000
    v_mov_b32 v48, 0
    v_mov_b32 v49, 0
    v_mov_b32 v50, 0
    v_mov_b32 v51, 0
    v_mov_b32 v52, 0
    v_mov_b32 v53, 0
    v_mov_b32 v54, 0
    v_mov_b32 v55, 0
    s_mul_i32 s63, s28, 2560
    v_lshlrev_b32 v7, 3, v1
    v_add_u32 v7, s63, v7
    s_waitcnt vmcnt(5)
    v_lshlrev_b32 v66, 16, v60
    v_and_b32 v67, 0xffff0000, v60
    v_lshlrev_b32 v68, 16, v61
    v_and_b32 v69, 0xffff0000, v61
    v_lshlrev_b32 v70, 16, v62
    v_and_b32 v71, 0xffff0000, v62
    v_lshlrev_b32 v72, 16, v63
    v_and_b32 v73, 0xffff0000, v63
    v_lshlrev_b32 v74, 16, v64
    v_and_b32 v75, 0xffff0000, v64
    v_add_f32 v76, v66, v67
    v_add_f32 v76, v76, v68
    v_add_f32 v76, v76, v69
    v_add_f32 v76, v76, v70
    v_add_f32 v76, v76, v71
    v_add_f32 v76, v76, v72
    v_add_f32 v76, v76, v73
    v_add_f32 v76, v76, v74
    v_add_f32 v76, v76, v75
    s_nop 1
    v_add_f32_dpp v77, v76, v76 quad_perm:[1,0,3,2] row_mask:0xf bank_mask:0xf
    s_nop 1
    v_add_f32_dpp v76, v77, v77 quad_perm:[2,3,0,1] row_mask:0xf bank_mask:0xf
    s_nop 1
    v_add_f32_dpp v77, v76, v76 row_half_mirror row_mask:0xf bank_mask:0xf
    s_nop 1
    v_add_f32_dpp v76, v77, v77 row_mirror row_mask:0xf bank_mask:0xf
    s_nop 1
    v_readlane_b32 s58, v76, 0
    v_readlane_b32 s59, v76, 16
    v_readlane_b32 s60, v76, 32
    v_readlane_b32 s61, v76, 48
    s_nop 1
    v_mov_b32 v76, s58
    v_add_f32 v76, s59, v76
    v_add_f32 v76, s60, v76
    v_add_f32 v76, s61, v76
    v_mul_f32 v76, 0x3acccccd, v76
    v_sub_f32 v78, v66, v76
    v_mul_f32 v77, v78, v78
    v_sub_f32 v78, v67, v76
    v_fmac_f32 v77, v78, v78
    v_sub_f32 v78, v68, v76
    v_fmac_f32 v77, v78, v78
    v_sub_f32 v78, v69, v76
    v_fmac_f32 v77, v78, v78
    v_sub_f32 v78, v70, v76
    v_fmac_f32 v77, v78, v78
    v_sub_f32 v78, v71, v76
    v_fmac_f32 v77, v78, v78
    v_sub_f32 v78, v72, v76
    v_fmac_f32 v77, v78, v78
    v_sub_f32 v78, v73, v76
    v_fmac_f32 v77, v78, v78
    v_sub_f32 v78, v74, v76
    v_fmac_f32 v77, v78, v78
    v_sub_f32 v78, v75, v76
    v_fmac_f32 v77, v78, v78
    s_nop 1
    v_add_f32_dpp v78, v77, v77 quad_perm:[1,0,3,2] row_mask:0xf bank_mask:0xf
    s_nop 1
    v_add_f32_dpp v77, v78, v78 quad_perm:[2,3,0,1] row_mask:0xf bank_mask:0xf
    s_nop 1
    v_add_f32_dpp v78, v77, v77 row_half_mirror row_mask:0xf bank_mask:0xf
    s_nop 1
    v_add_f32_dpp v77, v78, v78 row_mirror row_mask:0xf bank_mask:0xf
    s_nop 1
    v_readlane_b32 s58, v77, 0
    v_readlane_b32 s59, v77, 16
    v_readlane_b32 s60, v77, 32
    v_readlane_b32 s61, v77, 48
    s_nop 1
    v_mov_b32 v77, s58
    v_add_f32 v77, s59, v77
    v_add_f32 v77, s60, v77
    v_add_f32 v77, s61, v77
    v_mul_f32 v77, 0x3acccccd, v77
    v_cvt_pk_bf16_f32 v76, v76, v76
    v_and_b32 v76, 0xffff0000, v76
    v_cvt_pk_bf16_f32 v77, v77, v77
    v_and_b32 v77, 0xffff0000, v77
    v_add_f32 v77, 0x3727c5ac, v77
    v_cvt_pk_bf16_f32 v77, v77, v77
    v_and_b32 v77, 0xffff0000, v77
    v_sqrt_f32 v77, v77
    s_nop 0
    v_cvt_pk_bf16_f32 v77, v77, v77
    v_and_b32 v77, 0xffff0000, v77
    v_rcp_f32 v78, v77
    s_nop 0
    v_sub_f32 v66, v66, v76
    v_cvt_pk_bf16_f32 v66, v66, v66
    v_and_b32 v66, 0xffff0000, v66
    v_mul_f32 v60, v66, v78
    v_fma_f32 v61, -v60, v77, v66
    v_fma_f32 v66, v61, v78, v60
    v_cvt_pk_bf16_f32 v66, v66, v66
    v_and_b32 v66, 0xffff0000, v66
    v_sub_f32 v67, v67, v76
    v_cvt_pk_bf16_f32 v67, v67, v67
    v_and_b32 v67, 0xffff0000, v67
    v_mul_f32 v60, v67, v78
    v_fma_f32 v61, -v60, v77, v67
    v_fma_f32 v67, v61, v78, v60
    v_cvt_pk_bf16_f32 v67, v67, v67
    v_and_b32 v67, 0xffff0000, v67
    v_sub_f32 v68, v68, v76
    v_cvt_pk_bf16_f32 v68, v68, v68
    v_and_b32 v68, 0xffff0000, v68
    v_mul_f32 v60, v68, v78
    v_fma_f32 v61, -v60, v77, v68
    v_fma_f32 v68, v61, v78, v60
    v_cvt_pk_bf16_f32 v68, v68, v68
    v_and_b32 v68, 0xffff0000, v68
    v_sub_f32 v69, v69, v76
    v_cvt_pk_bf16_f32 v69, v69, v69
    v_and_b32 v69, 0xffff0000, v69
    v_mul_f32 v60, v69, v78
    v_fma_f32 v61, -v60, v77, v69
    v_fma_f32 v69, v61, v78, v60
    v_cvt_pk_bf16_f32 v69, v69, v69
    v_and_b32 v69, 0xffff0000, v69
    v_sub_f32 v70, v70, v76
    v_cvt_pk_bf16_f32 v70, v70, v70
    v_and_b32 v70, 0xffff0000, v70
    v_mul_f32 v60, v70, v78
    v_fma_f32 v61, -v60, v77, v70
    v_fma_f32 v70, v61, v78, v60
    v_cvt_pk_bf16_f32 v70, v70, v70
    v_and_b32 v70, 0xffff0000, v70
    v_sub_f32 v71, v71, v76
    v_cvt_pk_bf16_f32 v71, v71, v71
    v_and_b32 v71, 0xffff0000, v71
    v_mul_f32 v60, v71, v78
    v_fma_f32 v61, -v60, v77, v71
    v_fma_f32 v71, v61, v78, v60
    v_cvt_pk_bf16_f32 v71, v71, v71
    v_and_b32 v71, 0xffff0000, v71
    v_sub_f32 v72, v72, v76
    v_cvt_pk_bf16_f32 v72, v72, v72
    v_and_b32 v72, 0xffff0000, v72
    v_mul_f32 v60, v72, v78
    v_fma_f32 v61, -v60, v77, v72
    v_fma_f32 v72, v61, v78, v60
    v_cvt_pk_bf16_f32 v72, v72, v72
    v_and_b32 v72, 0xffff0000, v72
    v_sub_f32 v73, v73, v76
    v_cvt_pk_bf16_f32 v73, v73, v73
    v_and_b32 v73, 0xffff0000, v73
    v_mul_f32 v60, v73, v78
    v_fma_f32 v61, -v60, v77, v73
    v_fma_f32 v73, v61, v78, v60
    v_cvt_pk_bf16_f32 v73, v73, v73
    v_and_b32 v73, 0xffff0000, v73
    v_sub_f32 v74, v74, v76
    v_cvt_pk_bf16_f32 v74, v74, v74
    v_and_b32 v74, 0xffff0000, v74
    v_mul_f32 v60, v74, v78
    v_fma_f32 v61, -v60, v77, v74
    v_fma_f32 v74, v61, v78, v60
    v_cvt_pk_bf16_f32 v74, v74, v74
    v_and_b32 v74, 0xffff0000, v74
    v_sub_f32 v75, v75, v76
    v_cvt_pk_bf16_f32 v75, v75, v75
    v_and_b32 v75, 0xffff0000, v75
    v_mul_f32 v60, v75, v78
    v_fma_f32 v61, -v60, v77, v75
    v_fma_f32 v75, v61, v78, v60
    v_cvt_pk_bf16_f32 v75, v75, v75
    v_and_b32 v75, 0xffff0000, v75
    ds_write_b64 v7, v[66:67] offset:0
    ds_write_b64 v7, v[68:69] offset:512
    ds_write_b64 v7, v[70:71] offset:1024
    ds_write_b64 v7, v[72:73] offset:1536
    ds_write_b64 v7, v[74:75] offset:2048
    s_lshl_b32 s58, s31, 2
    s_add_u32 s58, s58, s63
    v_lshlrev_b32 v7, 2, v5
    v_add_u32 v7, s58, v7
    s_waitcnt lgkmcnt(0)
    ds_read_b32 v66, v7 offset:0
    ds_read_b32 v67, v7 offset:16
    ds_read_b32 v68, v7 offset:32
    ds_read_b32 v69, v7 offset:48
    ds_read_b32 v70, v7 offset:64
    s_waitcnt lgkmcnt(0)
    s_waitcnt vmcnt(4)
    v_lshlrev_b32 v56, 16, v8
    v_and_b32 v57, 0xffff0000, v8
    v_pk_fma_f32 v[48:49], v[56:57], v[66:67], v[48:49] op_sel_hi:[1,0,1]
    v_lshlrev_b32 v58, 16, v9
    v_and_b32 v59, 0xffff0000, v9
    v_pk_fma_f32 v[50:51], v[58:59], v[66:67], v[50:51] op_sel_hi:[1,0,1]
    v_lshlrev_b32 v56, 16, v10
    v_and_b32 v57, 0xffff0000, v10
    v_pk_fma_f32 v[52:53], v[56:57], v[66:67], v[52:53] op_sel_hi:[1,0,1]
    v_lshlrev_b32 v58, 16, v11
    v_and_b32 v59, 0xffff0000, v11
    v_pk_fma_f32 v[54:55], v[58:59], v[66:67], v[54:55] op_sel_hi:[1,0,1]
    s_waitcnt vmcnt(3)
    v_lshlrev_b32 v56, 16, v12
    v_and_b32 v57, 0xffff0000, v12
    v_pk_fma_f32 v[48:49], v[56:57], v[66:67], v[48:49] op_sel:[0,1,0] op_sel_hi:[1,1,1]
    v_lshlrev_b32 v58, 16, v13
    v_and_b32 v59, 0xffff0000, v13
    v_pk_fma_f32 v[50:51], v[58:59], v[66:67], v[50:51] op_sel:[0,1,0] op_sel_hi:[1,1,1]
    v_lshlrev_b32 v56, 16, v14
    v_and_b32 v57, 0xffff0000, v14
    v_pk_fma_f32 v[52:53], v[56:57], v[66:67], v[52:53] op_sel:[0,1,0] op_sel_hi:[1,1,1]
    v_lshlrev_b32 v58, 16, v15
    v_and_b32 v59, 0xffff0000, v15
    v_pk_fma_f32 v[54:55], v[58:59], v[66:67], v[54:55] op_sel:[0,1,0] op_sel_hi:[1,1,1]
    s_waitcnt vmcnt(2)
    v_lshlrev_b32 v56, 16, v16
    v_and_b32 v57, 0xffff0000, v16
    v_pk_fma_f32 v[48:49], v[56:57], v[68:69], v[48:49] op_sel_hi:[1,0,1]
    v_lshlrev_b32 v58, 16, v17
    v_and_b32 v59, 0xffff0000, v17
    v_pk_fma_f32 v[50:51], v[58:59], v[68:69], v[50:51] op_sel_hi:[1,0,1]
    v_lshlrev_b32 v56, 16, v18
    v_and_b32 v57, 0xffff0000, v18
    v_pk_fma_f32 v[52:53], v[56:57], v[68:69], v[52:53] op_sel_hi:[1,0,1]
    v_lshlrev_b32 v58, 16, v19
    v_and_b32 v59, 0xffff0000, v19
    v_pk_fma_f32 v[54:55], v[58:59], v[68:69], v[54:55] op_sel_hi:[1,0,1]
    s_waitcnt vmcnt(1)
    v_lshlrev_b32 v56, 16, v20
    v_and_b32 v57, 0xffff0000, v20
    v_pk_fma_f32 v[48:49], v[56:57], v[68:69], v[48:49] op_sel:[0,1,0] op_sel_hi:[1,1,1]
    v_lshlrev_b32 v58, 16, v21
    v_and_b32 v59, 0xffff0000, v21
    v_pk_fma_f32 v[50:51], v[58:59], v[68:69], v[50:51] op_sel:[0,1,0] op_sel_hi:[1,1,1]
    v_lshlrev_b32 v56, 16, v22
    v_and_b32 v57, 0xffff0000, v22
    v_pk_fma_f32 v[52:53], v[56:57], v[68:69], v[52:53] op_sel:[0,1,0] op_sel_hi:[1,1,1]
    v_lshlrev_b32 v58, 16, v23
    v_and_b32 v59, 0xffff0000, v23
    v_pk_fma_f32 v[54:55], v[58:59], v[68:69], v[54:55] op_sel:[0,1,0] op_sel_hi:[1,1,1]
    s_waitcnt vmcnt(0)
    v_lshlrev_b32 v56, 16, v24
    v_and_b32 v57, 0xffff0000, v24
    v_pk_fma_f32 v[48:49], v[56:57], v[70:71], v[48:49] op_sel_hi:[1,0,1]
    v_lshlrev_b32 v58, 16, v25
    v_and_b32 v59, 0xffff0000, v25
    v_pk_fma_f32 v[50:51], v[58:59], v[70:71], v[50:51] op_sel_hi:[1,0,1]
    v_lshlrev_b32 v56, 16, v26
    v_and_b32 v57, 0xffff0000, v26
    v_pk_fma_f32 v[52:53], v[56:57], v[70:71], v[52:53] op_sel_hi:[1,0,1]
    v_lshlrev_b32 v58, 16, v27
    v_and_b32 v59, 0xffff0000, v27
    v_pk_fma_f32 v[54:55], v[58:59], v[70:71], v[54:55] op_sel_hi:[1,0,1]
    s_nop 1
    v_permlane32_swap_b32 v48, v52
    v_permlane32_swap_b32 v49, v53
    v_permlane32_swap_b32 v50, v54
    v_permlane32_swap_b32 v51, v55
    v_add_f32 v48, v48, v52
    v_add_f32 v49, v49, v53
    v_add_f32 v50, v50, v54
    v_add_f32 v51, v51, v55
    s_nop 1
    v_permlane16_swap_b32 v48, v50
    v_permlane16_swap_b32 v49, v51
    v_add_f32 v48, v48, v50
    v_add_f32 v49, v49, v51
    v_lshlrev_b32 v7, 1, v6
    v_lshl_add_u32 v7, v5, 3, v7
    s_lshl_b32 s58, s28, 9
    v_add_u32 v7, s58, v7
    ds_write_b64 v7, v[48:49] offset:20480
    s_waitcnt lgkmcnt(0)
    s_barrier
    s_cmp_lg_u32 s28, 0
    s_cbranch_scc1 P_done
    v_lshlrev_b32 v7, 3, v1
    ds_read_b64 v[8:9], v7 offset:20480
    ds_read_b64 v[10:11], v7 offset:20992
    ds_read_b64 v[12:13], v7 offset:21504
    ds_read_b64 v[14:15], v7 offset:22016
    ds_read_b64 v[16:17], v7 offset:22528
    ds_read_b64 v[18:19], v7 offset:23040
    ds_read_b64 v[20:21], v7 offset:23552
    ds_read_b64 v[22:23], v7 offset:24064
    s_lshl_b32 s58, s56, 1
    s_add_u32 s58, s58, s29
    s_waitcnt lgkmcnt(0)
    v_pk_add_f32 v[8:9], v[8:9], v[10:11]
    v_pk_add_f32 v[8:9], v[8:9], v[12:13]
    v_pk_add_f32 v[8:9], v[8:9], v[14:15]
    v_pk_add_f32 v[8:9], v[8:9], v[16:17]
    v_pk_add_f32 v[8:9], v[8:9], v[18:19]
    v_pk_add_f32 v[8:9], v[8:9], v[20:21]
    v_pk_add_f32 v[8:9], v[8:9], v[22:23]
    buffer_store_dwordx2 v[8:9], v7, s[52:55], s58 offen
    s_cmp_lg_u32 s2, 0
    s_cbranch_scc1 P_done
    s_mov_b32 exec_lo, -1
    s_mov_b32 exec_hi, 0
    v_lshlrev_b32 v7, 8, v1
    v_mov_b32 v10, 256
    s_mov_b32 s58, 0
    buffer_store_dword v10, v7, s[52:55], s58 offen
P_done:
    s_endpgm
.globl attn_kernel
.p2align 8
.type attn_kernel,@function
attn_kernel:
    s_cmp_ge_u32 s2, 256
    s_cbranch_scc1 A_done
    s_load_dwordx4 s[4:7], s[0:1], 0
    s_load_dwordx2 s[8:9], s[0:1], 16
    s_load_dwordx2 s[26:27], s[0:1], 96
    v_and_b32 v1, 63, v0
    v_lshrrev_b32 v6, 6, v0
    s_lshr_b32 s29, s2, 3
    v_readfirstlane_b32 s28, v6
    s_and_b32 s30, s2, 7
    v_lshrrev_b32 v6, 3, v1
    v_and_b32 v7, 7, v1
    v_lshlrev_b32 v7, 4, v7
    v_mul_u32_u24 v2, 384, v6
    v_add_u32 v2, v2, v7
    v_mov_b32 v3, 1
    v_mov_b32 v4, 0
    s_mul_i32 s58, s29, 12582912
    s_mul_hi_u32 s59, s29, 12582912
    s_waitcnt lgkmcnt(0)
    s_mov_b32 s52, s26
    s_mov_b32 s53, s27
    s_mov_b32 s54, 1540096
    s_mov_b32 s55, 0x00020000
    s_cmp_eq_u32 s28, 8
    s_cbranch_scc1 A_sched
    s_add_u32 s32, s6, s58
    s_addc_u32 s33, s7, s59
    s_mov_b32 s34, 12582912
    s_mov_b32 s35, 0x00020000
    s_add_u32 s36, s8, s58
    s_addc_u32 s37, s9, s59
    s_mov_b32 s38, 12582912
    s_mov_b32 s39, 0x00020000
    s_mul_i32 s21, s29, 48
    s_and_b32 s21, s21, 4095
    s_mul_i32 s21, s21, 3072
    s_barrier
    s_add_u32 s58, s28, 0
    s_lshr_b32 s59, s58, 3
    s_and_b32 s58, s58, 7
    s_and_b32 s60, s59, 15
    s_lshr_b32 s59, s59, 4
    s_lshl_b32 s59, s59, 3
    s_add_u32 s59, s59, s30
    s_lshl_b32 s59, s59, 4
    s_add_u32 s59, s59, s60
    s_lshr_b32 s24, s59, 9
    s_lshl_b32 s59, s59, 3
    s_add_u32 s58, s58, s59
    s_mul_i32 s76, s58, 3072
    s_add_u32 s76, s76, s21
    s_sub_u32 s22, s76, 12582912
    s_cmp_ge_u32 s76, 12582912
    s_cselect_b32 s76, s22, s76
    buffer_load_dwordx4 v[8:11], v2, s[32:35], s76 offen offset:0 nt
    buffer_load_dwordx4 v[12:15], v2, s[32:35], s76 offen offset:128 nt
    buffer_load_dwordx4 v[16:19], v2, s[32:35], s76 offen offset:256 nt
    buffer_load_dwordx4 v[32:35], v2, s[36:39], s76 offen offset:0 nt
    buffer_load_dwordx4 v[36:39], v2, s[36:39], s76 offen offset:128 nt
    buffer_load_dwordx4 v[40:43], v2, s[36:39], s76 offen offset:256 nt
    s_add_u32 s58, s28, 8
    s_lshr_b32 s59, s58, 3
    s_and_b32 s58, s58, 7
    s_and_b32 s60, s59, 15
    s_lshr_b32 s59, s59, 4
    s_lshl_b32 s59, s59, 3
    s_add_u32 s59, s59, s30
    s_lshl_b32 s59, s59, 4
    s_add_u32 s59, s59, s60
    s_lshr_b32 s25, s59, 9
    s_lshl_b32 s59, s59, 3
    s_add_u32 s58, s58, s59
    s_mul_i32 s77, s58, 3072
    s_add_u32 s77, s77, s21
    s_sub_u32 s22, s77, 12582912
    s_cmp_ge_u32 s77, 12582912
    s_cselect_b32 s77, s22, s77
    buffer_load_dwordx4 v[20:23], v2, s[32:35], s77 offen offset:0 nt
    buffer_load_dwordx4 v[24:27], v2, s[32:35], s77 offen offset:128 nt
    buffer_load_dwordx4 v[28:31], v2, s[32:35], s77 offen offset:256 nt
    buffer_load_dwordx4 v[44:47], v2, s[36:39], s77 offen offset:0 nt
    buffer_load_dwordx4 v[48:51], v2, s[36:39], s77 offen offset:128 nt
    buffer_load_dwordx4 v[52:55], v2, s[36:39], s77 offen offset:256 nt
    v_mov_b32 v56, 0
    v_mov_b32 v57, 0
    v_mov_b32 v58, 0
    v_mov_b32 v59, 0
    v_mov_b32 v60, 0
    v_mov_b32 v61, 0
    v_mov_b32 v62, 0
    v_mov_b32 v63, 0
    v_mov_b32 v64, 0
    v_mov_b32 v65, 0
    v_mov_b32 v66, 0
    v_mov_b32 v67, 0
    v_mov_b32 v68, 0
    v_mov_b32 v69, 0
    v_mov_b32 v70, 0
    v_mov_b32 v71, 0
    v_mov_b32 v72, 0
    v_mov_b32 v73, 0
    v_mov_b32 v74, 0
    v_mov_b32 v75, 0
    v_mov_b32 v76, 0
    v_mov_b32 v77, 0
    v_mov_b32 v78, 0
    v_mov_b32 v79, 0
    v_mov_b32 v92, 0xf149f2ca
    v_mov_b32 v93, 0
    s_mul_i32 s58, s28, 768
    v_mul_u32_u24 v6, 12, v1
    v_add_u32 v6, s58, v6
    ds_write_b96 v6, v[56:58] offset:0
    s_lshl_b32 s58, s28, 3
    v_mov_b32 v6, s58
    ds_write_b64 v6, v[92:93] offset:6144
    s_mov_b32 s63, 0x3d93cd3a
    s_mov_b32 s84, 0
    s_mov_b32 s85, s24
    s_mul_i32 s58, s85, 384
    v_add_u32 v6, s58, v7
    s_waitcnt lgkmcnt(0)
A_qwait:
    ds_read_b32 v5, v4 offset:6660
    s_waitcnt lgkmcnt(0)
    v_readfirstlane_b32 s58, v5
    s_nop 3
    s_cmp_eq_u32 s58, 0
    s_cbranch_scc1 A_qwait
    ds_read_b128 v[80:83], v6 offset:7168
    ds_read_b128 v[84:87], v6 offset:7296
    ds_read_b128 v[88:91], v6 offset:7424
    s_waitcnt lgkmcnt(0)
.p2align 6
A_loop:
    s_cmp_ge_u32 s76, 12582912
    s_cbranch_scc1 A_loop_done
    s_cmp_lg_u32 s84, 0
    s_cbranch_scc1 A_nodraw1
    s_mov_b64 exec, 1
    ds_add_rtn_u32 v5, v4, v3 offset:6656
    s_mov_b64 exec, -1
    s_waitcnt lgkmcnt(0)
    v_readfirstlane_b32 s58, v5
    s_nop 3
    s_lshr_b32 s59, s58, 3
    s_lshl_b32 s59, s59, 2
    v_mov_b32 v6, s59
    s_and_b32 s58, s58, 7
    s_mul_i32 s58, s58, 3072
A_spin1:
    ds_read_b32 v5, v6 offset:10240
A_nodraw1:
    s_waitcnt vmcnt(9)
    v_dot2_f32_bf16 v94, v8, v80, 0
    v_dot2_f32_bf16 v95, v12, v84, 0
    v_dot2_f32_bf16 v96, v16, v88, 0
    v_dot2_f32_bf16 v94, v9, v81, v94
    v_dot2_f32_bf16 v95, v13, v85, v95
    v_dot2_f32_bf16 v96, v17, v89, v96
    v_dot2_f32_bf16 v94, v10, v82, v94
    v_dot2_f32_bf16 v95, v14, v86, v95
    v_dot2_f32_bf16 v96, v18, v90, v96
    v_dot2_f32_bf16 v94, v11, v83, v94
    v_dot2_f32_bf16 v95, v15, v87, v95
    v_dot2_f32_bf16 v96, v19, v91, v96
    s_mov_b32 s76, 0x7ffffff0
    s_cmp_lg_u32 s84, 0
    s_cbranch_scc1 A_have1
    s_waitcnt lgkmcnt(0)
    v_readfirstlane_b32 s59, v5
    s_nop 3
    s_cmp_eq_u32 s59, 0
    s_cbranch_scc1 A_spin1
    s_bfe_u32 s24, s59, 0x40001
    s_and_b32 s59, s59, 0xfffffc00
    s_add_u32 s76, s59, s58
    s_cmp_ge_u32 s76, 12582912
    s_cselect_b32 s84, 1, 0
    s_cbranch_scc1 A_have1
    s_add_u32 s76, s76, s21
    s_sub_u32 s22, s76, 12582912
    s_cmp_ge_u32 s76, 12582912
    s_cselect_b32 s76, s22, s76
A_have1:
    buffer_load_dwordx4 v[8:11], v2, s[32:35], s76 offen offset:0 nt
    buffer_load_dwordx4 v[12:15], v2, s[32:35], s76 offen offset:128 nt
    buffer_load_dwordx4 v[16:19], v2, s[32:35], s76 offen offset:256 nt
    v_add_f32 v94, v94, v95
    v_add_f32 v94, v94, v96
    s_nop 1
    v_add_f32_dpp v95, v94, v94 quad_perm:[1,0,3,2] row_mask:0xf bank_mask:0xf
    s_nop 1
    v_add_f32_dpp v94, v95, v95 quad_perm:[2,3,0,1] row_mask:0xf bank_mask:0xf
    s_nop 1
    v_add_f32_dpp v95, v94, v94 row_half_mirror row_mask:0xf bank_mask:0xf
    v_cvt_pk_bf16_f32 v95, v95, v95
    v_and_b32 v95, 0xffff0000, v95
    v_mul_f32 v95, s63, v95
    v_cvt_pk_bf16_f32 v95, v95, v95
    v_and_b32 v95, 0xffff0000, v95
    v_mul_f32 v95, 0x3fb8aa3b, v95
    v_max_f32 v96, v92, v95
    v_sub_f32 v100, v92, v96
    v_sub_f32 v98, v95, v96
    v_exp_f32 v100, v100
    v_exp_f32 v98, v98
    v_mov_b32 v92, v96
    v_fma_f32 v93, v93, v100, v98
    v_pk_mul_f32 v[56:57], v[56:57], v[100:101] op_sel_hi:[1,0]
    v_pk_mul_f32 v[58:59], v[58:59], v[100:101] op_sel_hi:[1,0]
    v_pk_mul_f32 v[60:61], v[60:61], v[100:101] op_sel_hi:[1,0]
    v_pk_mul_f32 v[62:63], v[62:63], v[100:101] op_sel_hi:[1,0]
    v_pk_mul_f32 v[64:65], v[64:65], v[100:101] op_sel_hi:[1,0]
    v_pk_mul_f32 v[66:67], v[66:67], v[100:101] op_sel_hi:[1,0]
    v_pk_mul_f32 v[68:69], v[68:69], v[100:101] op_sel_hi:[1,0]
    v_pk_mul_f32 v[70:71], v[70:71], v[100:101] op_sel_hi:[1,0]
    v_pk_mul_f32 v[72:73], v[72:73], v[100:101] op_sel_hi:[1,0]
    v_pk_mul_f32 v[74:75], v[74:75], v[100:101] op_sel_hi:[1,0]
    v_pk_mul_f32 v[76:77], v[76:77], v[100:101] op_sel_hi:[1,0]
    v_pk_mul_f32 v[78:79], v[78:79], v[100:101] op_sel_hi:[1,0]
    s_waitcnt vmcnt(9)
    v_lshlrev_b32 v102, 16, v32
    v_and_b32 v103, 0xffff0000, v32
    v_pk_fma_f32 v[56:57], v[102:103], v[98:99], v[56:57] op_sel_hi:[1,0,1]
    v_lshlrev_b32 v104, 16, v33
    v_and_b32 v105, 0xffff0000, v33
    v_pk_fma_f32 v[58:59], v[104:105], v[98:99], v[58:59] op_sel_hi:[1,0,1]
    v_lshlrev_b32 v106, 16, v34
    v_and_b32 v107, 0xffff0000, v34
    v_pk_fma_f32 v[60:61], v[106:107], v[98:99], v[60:61] op_sel_hi:[1,0,1]
    v_lshlrev_b32 v108, 16, v35
    v_and_b32 v109, 0xffff0000, v35
    v_pk_fma_f32 v[62:63], v[108:109], v[98:99], v[62:63] op_sel_hi:[1,0,1]
    v_lshlrev_b32 v102, 16, v36
    v_and_b32 v103, 0xffff0000, v36
    v_pk_fma_f32 v[64:65], v[102:103], v[98:99], v[64:65] op_sel_hi:[1,0,1]
    v_lshlrev_b32 v104, 16, v37
    v_and_b32 v105, 0xffff0000, v37
    v_pk_fma_f32 v[66:67], v[104:105], v[98:99], v[66:67] op_sel_hi:[1,0,1]
    v_lshlrev_b32 v106, 16, v38
    v_and_b32 v107, 0xffff0000, v38
    v_pk_fma_f32 v[68:69], v[106:107], v[98:99], v[68:69] op_sel_hi:[1,0,1]
    v_lshlrev_b32 v108, 16, v39
    v_and_b32 v109, 0xffff0000, v39
    v_pk_fma_f32 v[70:71], v[108:109], v[98:99], v[70:71] op_sel_hi:[1,0,1]
    v_lshlrev_b32 v102, 16, v40
    v_and_b32 v103, 0xffff0000, v40
    v_pk_fma_f32 v[72:73], v[102:103], v[98:99], v[72:73] op_sel_hi:[1,0,1]
    v_lshlrev_b32 v104, 16, v41
    v_and_b32 v105, 0xffff0000, v41
    v_pk_fma_f32 v[74:75], v[104:105], v[98:99], v[74:75] op_sel_hi:[1,0,1]
    v_lshlrev_b32 v106, 16, v42
    v_and_b32 v107, 0xffff0000, v42
    v_pk_fma_f32 v[76:77], v[106:107], v[98:99], v[76:77] op_sel_hi:[1,0,1]
    v_lshlrev_b32 v108, 16, v43
    v_and_b32 v109, 0xffff0000, v43
    v_pk_fma_f32 v[78:79], v[108:109], v[98:99], v[78:79] op_sel_hi:[1,0,1]
    buffer_load_dwordx4 v[32:35], v2, s[36:39], s76 offen offset:0 nt
    buffer_load_dwordx4 v[36:39], v2, s[36:39], s76 offen offset:128 nt
    buffer_load_dwordx4 v[40:43], v2, s[36:39], s76 offen offset:256 nt
    s_cmp_ge_u32 s77, 12582912
    s_cbranch_scc1 A_loop_done
    s_cmp_lg_u32 s84, 0
    s_cbranch_scc1 A_nodraw2
    s_mov_b64 exec, 1
    ds_add_rtn_u32 v5, v4, v3 offset:6656
    s_mov_b64 exec, -1
    s_waitcnt lgkmcnt(0)
    v_readfirstlane_b32 s58, v5
    s_nop 3
    s_lshr_b32 s59, s58, 3
    s_lshl_b32 s59, s59, 2
    v_mov_b32 v6, s59
    s_and_b32 s58, s58, 7
    s_mul_i32 s58, s58, 3072
A_spin2:
    ds_read_b32 v5, v6 offset:10240
A_nodraw2:
    s_waitcnt vmcnt(9)
    v_dot2_f32_bf16 v94, v20, v80, 0
    v_dot2_f32_bf16 v95, v24, v84, 0
    v_dot2_f32_bf16 v96, v28, v88, 0
    v_dot2_f32_bf16 v94, v21, v81, v94
    v_dot2_f32_bf16 v95, v25, v85, v95
    v_dot2_f32_bf16 v96, v29, v89, v96
    v_dot2_f32_bf16 v94, v22, v82, v94
    v_dot2_f32_bf16 v95, v26, v86, v95
    v_dot2_f32_bf16 v96, v30, v90, v96
    v_dot2_f32_bf16 v94, v23, v83, v94
    v_dot2_f32_bf16 v95, v27, v87, v95
    v_dot2_f32_bf16 v96, v31, v91, v96
    s_mov_b32 s77, 0x7ffffff0
    s_cmp_lg_u32 s84, 0
    s_cbranch_scc1 A_have2
    s_waitcnt lgkmcnt(0)
    v_readfirstlane_b32 s59, v5
    s_nop 3
    s_cmp_eq_u32 s59, 0
    s_cbranch_scc1 A_spin2
    s_bfe_u32 s25, s59, 0x40001
    s_and_b32 s59, s59, 0xfffffc00
    s_add_u32 s77, s59, s58
    s_cmp_ge_u32 s77, 12582912
    s_cselect_b32 s84, 1, 0
    s_cbranch_scc1 A_have2
    s_add_u32 s77, s77, s21
    s_sub_u32 s22, s77, 12582912
    s_cmp_ge_u32 s77, 12582912
    s_cselect_b32 s77, s22, s77
A_have2:
    buffer_load_dwordx4 v[20:23], v2, s[32:35], s77 offen offset:0 nt
    buffer_load_dwordx4 v[24:27], v2, s[32:35], s77 offen offset:128 nt
    buffer_load_dwordx4 v[28:31], v2, s[32:35], s77 offen offset:256 nt
    v_add_f32 v94, v94, v95
    v_add_f32 v94, v94, v96
    s_nop 1
    v_add_f32_dpp v95, v94, v94 quad_perm:[1,0,3,2] row_mask:0xf bank_mask:0xf
    s_nop 1
    v_add_f32_dpp v94, v95, v95 quad_perm:[2,3,0,1] row_mask:0xf bank_mask:0xf
    s_nop 1
    v_add_f32_dpp v95, v94, v94 row_half_mirror row_mask:0xf bank_mask:0xf
    v_cvt_pk_bf16_f32 v95, v95, v95
    v_and_b32 v95, 0xffff0000, v95
    v_mul_f32 v95, s63, v95
    v_cvt_pk_bf16_f32 v95, v95, v95
    v_and_b32 v95, 0xffff0000, v95
    v_mul_f32 v95, 0x3fb8aa3b, v95
    v_max_f32 v96, v92, v95
    v_sub_f32 v100, v92, v96
    v_sub_f32 v98, v95, v96
    v_exp_f32 v100, v100
    v_exp_f32 v98, v98
    v_mov_b32 v92, v96
    v_fma_f32 v93, v93, v100, v98
    v_pk_mul_f32 v[56:57], v[56:57], v[100:101] op_sel_hi:[1,0]
    v_pk_mul_f32 v[58:59], v[58:59], v[100:101] op_sel_hi:[1,0]
    v_pk_mul_f32 v[60:61], v[60:61], v[100:101] op_sel_hi:[1,0]
    v_pk_mul_f32 v[62:63], v[62:63], v[100:101] op_sel_hi:[1,0]
    v_pk_mul_f32 v[64:65], v[64:65], v[100:101] op_sel_hi:[1,0]
    v_pk_mul_f32 v[66:67], v[66:67], v[100:101] op_sel_hi:[1,0]
    v_pk_mul_f32 v[68:69], v[68:69], v[100:101] op_sel_hi:[1,0]
    v_pk_mul_f32 v[70:71], v[70:71], v[100:101] op_sel_hi:[1,0]
    v_pk_mul_f32 v[72:73], v[72:73], v[100:101] op_sel_hi:[1,0]
    v_pk_mul_f32 v[74:75], v[74:75], v[100:101] op_sel_hi:[1,0]
    v_pk_mul_f32 v[76:77], v[76:77], v[100:101] op_sel_hi:[1,0]
    v_pk_mul_f32 v[78:79], v[78:79], v[100:101] op_sel_hi:[1,0]
    s_waitcnt vmcnt(9)
    v_lshlrev_b32 v102, 16, v44
    v_and_b32 v103, 0xffff0000, v44
    v_pk_fma_f32 v[56:57], v[102:103], v[98:99], v[56:57] op_sel_hi:[1,0,1]
    v_lshlrev_b32 v104, 16, v45
    v_and_b32 v105, 0xffff0000, v45
    v_pk_fma_f32 v[58:59], v[104:105], v[98:99], v[58:59] op_sel_hi:[1,0,1]
    v_lshlrev_b32 v106, 16, v46
    v_and_b32 v107, 0xffff0000, v46
    v_pk_fma_f32 v[60:61], v[106:107], v[98:99], v[60:61] op_sel_hi:[1,0,1]
    v_lshlrev_b32 v108, 16, v47
    v_and_b32 v109, 0xffff0000, v47
    v_pk_fma_f32 v[62:63], v[108:109], v[98:99], v[62:63] op_sel_hi:[1,0,1]
    v_lshlrev_b32 v102, 16, v48
    v_and_b32 v103, 0xffff0000, v48
    v_pk_fma_f32 v[64:65], v[102:103], v[98:99], v[64:65] op_sel_hi:[1,0,1]
    v_lshlrev_b32 v104, 16, v49
    v_and_b32 v105, 0xffff0000, v49
    v_pk_fma_f32 v[66:67], v[104:105], v[98:99], v[66:67] op_sel_hi:[1,0,1]
    v_lshlrev_b32 v106, 16, v50
    v_and_b32 v107, 0xffff0000, v50
    v_pk_fma_f32 v[68:69], v[106:107], v[98:99], v[68:69] op_sel_hi:[1,0,1]
    v_lshlrev_b32 v108, 16, v51
    v_and_b32 v109, 0xffff0000, v51
    v_pk_fma_f32 v[70:71], v[108:109], v[98:99], v[70:71] op_sel_hi:[1,0,1]
    v_lshlrev_b32 v102, 16, v52
    v_and_b32 v103, 0xffff0000, v52
    v_pk_fma_f32 v[72:73], v[102:103], v[98:99], v[72:73] op_sel_hi:[1,0,1]
    v_lshlrev_b32 v104, 16, v53
    v_and_b32 v105, 0xffff0000, v53
    v_pk_fma_f32 v[74:75], v[104:105], v[98:99], v[74:75] op_sel_hi:[1,0,1]
    v_lshlrev_b32 v106, 16, v54
    v_and_b32 v107, 0xffff0000, v54
    v_pk_fma_f32 v[76:77], v[106:107], v[98:99], v[76:77] op_sel_hi:[1,0,1]
    v_lshlrev_b32 v108, 16, v55
    v_and_b32 v109, 0xffff0000, v55
    v_pk_fma_f32 v[78:79], v[108:109], v[98:99], v[78:79] op_sel_hi:[1,0,1]
    buffer_load_dwordx4 v[44:47], v2, s[36:39], s77 offen offset:0 nt
    buffer_load_dwordx4 v[48:51], v2, s[36:39], s77 offen offset:128 nt
    buffer_load_dwordx4 v[52:55], v2, s[36:39], s77 offen offset:256 nt
    s_branch A_loop
A_loop_done:
    s_mov_b32 s23, 2
A_flush:
    v_mov_b32 v94, v92
    s_nop 1
    v_max_f32_dpp v95, v94, v94 row_ror:8 row_mask:0xf bank_mask:0xf
    s_nop 1
    v_readlane_b32 s58, v95, 0
    v_readlane_b32 s59, v95, 16
    v_readlane_b32 s60, v95, 32
    v_readlane_b32 s61, v95, 48
    s_nop 1
    v_mov_b32 v95, s58
    v_max_f32 v95, s59, v95
    v_max_f32 v95, s60, v95
    v_max_f32 v95, s61, v95
    v_sub_f32 v100, v92, v95
    v_exp_f32 v100, v100
    s_nop 0
    v_mul_f32 v93, v93, v100
    v_pk_mul_f32 v[56:57], v[56:57], v[100:101] op_sel_hi:[1,0]
    v_pk_mul_f32 v[58:59], v[58:59], v[100:101] op_sel_hi:[1,0]
    v_pk_mul_f32 v[60:61], v[60:61], v[100:101] op_sel_hi:[1,0]
    v_pk_mul_f32 v[62:63], v[62:63], v[100:101] op_sel_hi:[1,0]
    v_pk_mul_f32 v[64:65], v[64:65], v[100:101] op_sel_hi:[1,0]
    v_pk_mul_f32 v[66:67], v[66:67], v[100:101] op_sel_hi:[1,0]
    v_pk_mul_f32 v[68:69], v[68:69], v[100:101] op_sel_hi:[1,0]
    v_pk_mul_f32 v[70:71], v[70:71], v[100:101] op_sel_hi:[1,0]
    v_pk_mul_f32 v[72:73], v[72:73], v[100:101] op_sel_hi:[1,0]
    v_pk_mul_f32 v[74:75], v[74:75], v[100:101] op_sel_hi:[1,0]
    v_pk_mul_f32 v[76:77], v[76:77], v[100:101] op_sel_hi:[1,0]
    v_pk_mul_f32 v[78:79], v[78:79], v[100:101] op_sel_hi:[1,0]
    v_add_f32_dpp v96, v93, v93 row_ror:8 row_mask:0xf bank_mask:0xf
    s_nop 1
    v_readlane_b32 s58, v96, 0
    v_readlane_b32 s59, v96, 16
    v_readlane_b32 s60, v96, 32
    v_readlane_b32 s61, v96, 48
    s_nop 1
    v_mov_b32 v96, s58
    v_add_f32 v96, s59, v96
    v_add_f32 v96, s60, v96
    v_add_f32 v96, s61, v96
    s_nop 1
    v_permlane32_swap_b32 v56, v68
    v_permlane32_swap_b32 v57, v69
    v_permlane32_swap_b32 v58, v70
    v_permlane32_swap_b32 v59, v71
    v_permlane32_swap_b32 v60, v72
    v_permlane32_swap_b32 v61, v73
    v_permlane32_swap_b32 v62, v74
    v_permlane32_swap_b32 v63, v75
    v_permlane32_swap_b32 v64, v76
    v_permlane32_swap_b32 v65, v77
    v_permlane32_swap_b32 v66, v78
    v_permlane32_swap_b32 v67, v79
    v_add_f32 v56, v56, v68
    v_add_f32 v57, v57, v69
    v_add_f32 v58, v58, v70
    v_add_f32 v59, v59, v71
    v_add_f32 v60, v60, v72
    v_add_f32 v61, v61, v73
    v_add_f32 v62, v62, v74
    v_add_f32 v63, v63, v75
    v_add_f32 v64, v64, v76
    v_add_f32 v65, v65, v77
    v_add_f32 v66, v66, v78
    v_add_f32 v67, v67, v79
    s_nop 1
    v_permlane16_swap_b32 v56, v62
    v_permlane16_swap_b32 v57, v63
    v_permlane16_swap_b32 v58, v64
    v_permlane16_swap_b32 v59, v65
    v_permlane16_swap_b32 v60, v66
    v_permlane16_swap_b32 v61, v67
    v_add_f32 v56, v56, v62
    v_add_f32 v57, v57, v63
    v_add_f32 v58, v58, v64
    v_add_f32 v59, v59, v65
    v_add_f32 v60, v60, v66
    v_add_f32 v61, v61, v67
    s_nop 1
    v_add_f32_dpp v62, v56, v56 row_ror:8 row_mask:0xf bank_mask:0xf
    v_add_f32_dpp v63, v57, v57 row_ror:8 row_mask:0xf bank_mask:0xf
    v_add_f32_dpp v64, v58, v58 row_ror:8 row_mask:0xf bank_mask:0xf
    v_add_f32_dpp v65, v59, v59 row_ror:8 row_mask:0xf bank_mask:0xf
    v_add_f32_dpp v66, v60, v60 row_ror:8 row_mask:0xf bank_mask:0xf
    v_add_f32_dpp v67, v61, v61 row_ror:8 row_mask:0xf bank_mask:0xf
    v_and_b32 v7, 7, v1
    v_mul_u32_u24 v7, 96, v7
    v_lshrrev_b32 v97, 4, v1
    v_mul_u32_u24 v97, 24, v97
    v_add_u32 v7, v7, v97
    s_lshl_b32 s59, s85, 3
    s_add_u32 s59, s59, s28
    s_mul_i32 s58, s59, 768
    v_add_u32 v7, s58, v7
    ds_write_b64 v7, v[62:63] offset:0
    ds_write_b64 v7, v[64:65] offset:8
    ds_write_b64 v7, v[66:67] offset:16
    s_lshl_b32 s58, s59, 3
    v_mov_b32 v7, s58
    v_mov_b32 v98, v95
    v_mov_b32 v99, v96
    ds_write_b64 v7, v[98:99] offset:6144
    s_waitcnt lgkmcnt(0)
    s_barrier
    v_and_b32 v2, 0xff, v0
    v_cmp_gt_u32 vcc, 192, v2
    s_and_saveexec_b64 s[70:71], vcc
    s_cbranch_execz A_done
    s_lshr_b32 s85, s28, 2
    s_cmp_lg_u32 s85, 0
    s_cbranch_scc1 A_done
    v_mul_u32_u24 v6, 171, v2
    v_lshrrev_b32 v6, 12, v6
    v_mul_u32_u24 v7, 24, v6
    v_sub_u32 v7, v2, v7
    v_lshrrev_b32 v97, 3, v7
    v_lshlrev_b32 v97, 6, v97
    v_and_b32 v7, 7, v7
    v_add_u32 v7, v7, v97
    v_lshl_add_u32 v7, v6, 3, v7
    v_lshlrev_b32 v5, 2, v7
    v_lshlrev_b32 v2, 2, v2
A_s2loop:
    s_mul_i32 s58, s85, 6144
    v_add_u32 v7, s58, v2
    s_lshl_b32 s58, s85, 6
    v_mov_b32 v6, s58
    ds_read_b32 v56, v7 offset:0
    ds_read_b32 v57, v7 offset:768
    ds_read_b32 v58, v7 offset:1536
    ds_read_b32 v59, v7 offset:2304
    ds_read_b32 v60, v7 offset:3072
    ds_read_b32 v61, v7 offset:3840
    ds_read_b32 v62, v7 offset:4608
    ds_read_b32 v63, v7 offset:5376
    ds_read_b128 v[64:67], v6 offset:6144
    ds_read_b128 v[68:71], v6 offset:6160
    ds_read_b128 v[72:75], v6 offset:6176
    ds_read_b128 v[76:79], v6 offset:6192
    s_waitcnt lgkmcnt(0)
    v_max_f32 v94, v64, v66
    v_max_f32 v94, v94, v68
    v_max_f32 v94, v94, v70
    v_max_f32 v94, v94, v72
    v_max_f32 v94, v94, v74
    v_max_f32 v94, v94, v76
    v_max_f32 v94, v94, v78
    v_sub_f32 v64, v64, v94
    v_sub_f32 v66, v66, v94
    v_sub_f32 v68, v68, v94
    v_sub_f32 v70, v70, v94
    v_sub_f32 v72, v72, v94
    v_sub_f32 v74, v74, v94
    v_sub_f32 v76, v76, v94
    v_sub_f32 v78, v78, v94
    v_exp_f32 v64, v64
    v_exp_f32 v66, v66
    v_exp_f32 v68, v68
    v_exp_f32 v70, v70
    v_exp_f32 v72, v72
    v_exp_f32 v74, v74
    v_exp_f32 v76, v76
    v_exp_f32 v78, v78
    s_nop 0
    v_mul_f32 v95, v56, v64
    v_mul_f32 v99, v65, v64
    v_fmac_f32 v95, v57, v66
    v_fmac_f32 v99, v67, v66
    v_fmac_f32 v95, v58, v68
    v_fmac_f32 v99, v69, v68
    v_fmac_f32 v95, v59, v70
    v_fmac_f32 v99, v71, v70
    v_fmac_f32 v95, v60, v72
    v_fmac_f32 v99, v73, v72
    v_fmac_f32 v95, v61, v74
    v_fmac_f32 v99, v75, v74
    v_fmac_f32 v95, v62, v76
    v_fmac_f32 v99, v77, v76
    v_fmac_f32 v95, v63, v78
    v_fmac_f32 v99, v79, v78
    v_mov_b32 v98, v94
    s_lshl_b32 s59, s2, 0
    s_add_u32 s59, s59, s85
    s_mul_i32 s58, s59, 768
    s_add_u32 s58, s58, 196608
    buffer_store_dword v95, v5, s[52:55], s58 offen
    s_lshl_b32 s58, s59, 3
    s_add_u32 s58, s58, 16384
    s_and_b32 s60, s28, 3
    s_cmp_lg_u32 s60, 0
    s_cbranch_scc1 A_s2next
    s_mov_b64 s[70:71], exec
    s_mov_b64 exec, 1
    buffer_store_dwordx2 v[98:99], v4, s[52:55], s58 offen
    s_mov_b64 exec, s[70:71]
A_s2next:
    s_nop 1
    s_add_u32 s85, s85, 2
    s_cmp_lt_u32 s85, 1
    s_cbranch_scc1 A_s2loop
    s_endpgm
A_sched:
    s_mul_i32 s58, s29, 768
    s_add_u32 s58, s58, 65536
    v_lshlrev_b32 v7, 4, v1
    buffer_load_dwordx4 v[12:15], v7, s[52:55], s58 offen
    s_add_u32 s58, s58, 24576
    buffer_load_dwordx4 v[16:19], v7, s[52:55], s58 offen
    s_add_u32 s58, s58, 24576
    buffer_load_dwordx4 v[20:23], v7, s[52:55], s58 offen
    s_add_u32 s58, s58, 24576
    buffer_load_dwordx4 v[24:27], v7, s[52:55], s58 offen
    s_add_u32 s58, s58, 24576
    ds_write_b32 v4, v4 offset:6660
    v_mov_b32 v8, 16
    ds_write_b32 v4, v8 offset:6656
    v_lshlrev_b32 v6, 2, v1
    v_lshrrev_b32 v8, 4, v1
    v_lshlrev_b32 v8, 3, v8
    v_add_u32 v8, s30, v8
    v_and_b32 v9, 15, v1
    v_lshl_add_u32 v8, v8, 4, v9
    v_lshrrev_b32 v9, 9, v8
    v_lshlrev_b32 v9, 1, v9
    v_mul_u32_u24 v8, 24576, v8
    v_or_b32 v8, 1, v8
    v_or_b32 v8, v9, v8
    v_cmp_gt_u32 vcc, 32, v1
    s_nop 1
    v_cndmask_b32 v8, 0, v8, vcc
    ds_write_b32 v6, v8 offset:10240
    ds_write_b32 v6, v4 offset:10496
    ds_write_b32 v6, v4 offset:10752
    ds_write_b32 v6, v4 offset:11008
    ds_write_b32 v6, v4 offset:11264
    ds_write_b32 v6, v4 offset:11520
    ds_write_b32 v6, v4 offset:11776
    ds_write_b32 v6, v4 offset:12032
    s_waitcnt lgkmcnt(0)
    s_barrier
    s_waitcnt vmcnt(0)
    v_pk_add_f32 v[12:13], v[12:13], v[16:17]
    v_pk_add_f32 v[14:15], v[14:15], v[18:19]
    v_pk_add_f32 v[12:13], v[12:13], v[20:21]
    v_pk_add_f32 v[14:15], v[14:15], v[22:23]
    v_pk_add_f32 v[12:13], v[12:13], v[24:25]
    v_pk_add_f32 v[14:15], v[14:15], v[26:27]
    v_cvt_pk_bf16_f32 v12, v12, v13
    v_cvt_pk_bf16_f32 v13, v14, v15
    v_lshlrev_b32 v7, 3, v1
    s_mov_b32 exec_lo, -1
    s_mov_b32 exec_hi, 0xffff
    ds_write_b64 v7, v[12:13] offset:7168
    s_mov_b64 exec, 1
    s_waitcnt lgkmcnt(0)
    ds_write_b32 v4, v3 offset:6660
    s_lshl_b32 s56, s29, 8
    s_add_u32 s56, s56, 0
    s_mov_b32 s57, 32
    s_mov_b32 s62, 16
S_loop:
    s_sub_u32 s60, s57, 2
    s_lshl_b32 s60, s60, 3
S_poll:
    ds_read_b32 v8, v4 offset:6656
    s_waitcnt lgkmcnt(0)
    v_readfirstlane_b32 s58, v8
    s_nop 3
    s_cmp_ge_u32 s58, s60
    s_cbranch_scc1 S_go
    s_sleep 4
    s_branch S_poll
S_go:
    v_mov_b32 v9, s62
    buffer_atomic_add v9, v4, s[52:55], s56 offen sc0 sc1
    s_waitcnt vmcnt(0)
    v_readfirstlane_b32 s58, v9
    s_nop 3
S_fill:
    s_mov_b32 s59, s58
    s_mul_i32 s59, s59, 24576
    s_lshr_b32 s61, s58, 9
    s_lshl_b32 s61, s61, 1
    s_or_b32 s59, s59, s61
    s_or_b32 s59, s59, 1
    s_cmp_ge_u32 s58, 512
    s_cselect_b32 s59, 0x70000001, s59
    s_lshl_b32 s61, s57, 2
    v_mov_b32 v8, s61
    v_mov_b32 v9, s59
    ds_write_b32 v8, v9 offset:10240
    s_add_u32 s57, s57, 1
    s_cmp_ge_u32 s58, 512
    s_cbranch_scc1 S_end
    s_add_u32 s58, s58, 1
    s_sub_u32 s62, s62, 1
    s_cmp_lg_u32 s62, 0
    s_cbranch_scc1 S_fill
    s_mov_b32 s62, 16
    s_cmp_ge_u32 s58, 112
    s_cselect_b32 s62, 8, s62
    s_cmp_ge_u32 s58, 312
    s_cselect_b32 s62, 4, s62
    s_cmp_ge_u32 s58, 412
    s_cselect_b32 s62, 2, s62
    s_cmp_ge_u32 s58, 462
    s_cselect_b32 s62, 1, s62
    s_branch S_loop
S_end:
    s_waitcnt lgkmcnt(0)
A_done:
    s_endpgm
.globl oproj_kernel
.p2align 8
.type oproj_kernel,@function
oproj_kernel:
    s_cmp_ge_u32 s2, 256
    s_cbranch_scc1 O_done
    s_load_dwordx2 s[14:15], s[0:1], 32
    s_load_dwordx2 s[12:13], s[0:1], 64
    s_load_dwordx2 s[18:19], s[0:1], 56
    s_load_dwordx2 s[26:27], s[0:1], 96
    v_and_b32 v1, 63, v0
    v_lshrrev_b32 v2, 6, v0
    v_lshlrev_b32 v4, 4, v1
    v_readfirstlane_b32 s28, v2
    v_and_b32 v5, 7, v1
    v_cmp_gt_u32 s[64:65], 16, v1
    v_cmp_gt_u32 s[66:67], 32, v1
    v_cmp_gt_u32 s[68:69], 48, v1
    s_waitcnt lgkmcnt(0)
    s_mov_b32 s52, s26
    s_mov_b32 s53, s27
    s_mov_b32 s54, 1540096
    s_mov_b32 s55, 0x00020000
    s_cmp_ge_u32 s28, 6
    s_cbranch_scc1 O_w2
    s_mul_i32 s56, s28, 5120
    s_mov_b32 s40, s14
    s_mov_b32 s41, s15
    s_mov_b32 s42, 7864320
    s_mov_b32 s43, 0x00020000
    s_mul_i32 s58, s2, 30720
    s_add_u32 s56, s56, s58
    s_lshr_b32 s58, s2, 3
    s_and_b32 s61, s58, 0
    s_lshr_b32 s58, s58, 0
    s_lshl_b32 s58, s58, 3
    s_add_u32 s58, s58, s61
    s_lshl_b32 s59, s58, 3
    s_add_u32 s59, s59, 16384
    v_lshlrev_b32 v6, 3, v5
    buffer_load_dwordx2 v[32:33], v6, s[52:55], s59 offen
    s_mul_i32 s59, s58, 768
    s_and_b32 s60, s2, 7
    s_mul_i32 s60, s60, 96
    s_add_u32 s59, s59, s60
    s_lshl_b32 s60, s28, 4
    s_add_u32 s59, s59, s60
    s_add_u32 s59, s59, 196608
    v_mul_u32_u24 v6, 768, v5
    buffer_load_dwordx4 v[28:31], v6, s[52:55], s59 offen
    s_add_u32 s62, s56, 4096
    buffer_load_dwordx4 v[8:11], v4, s[40:43], s56 offen offset:0 nt
    buffer_load_dwordx4 v[12:15], v4, s[40:43], s56 offen offset:1024 nt
    buffer_load_dwordx4 v[16:19], v4, s[40:43], s56 offen offset:2048 nt
    buffer_load_dwordx4 v[20:23], v4, s[40:43], s56 offen offset:3072 nt
    buffer_load_dwordx4 v[24:27], v4, s[40:43], s62 offen nt
    s_waitcnt vmcnt(6)
    v_mov_b32 v34, v32
    s_nop 1
    v_max_f32_dpp v35, v34, v34 quad_perm:[1,0,3,2] row_mask:0xf bank_mask:0xf
    s_nop 1
    v_max_f32_dpp v34, v35, v35 quad_perm:[2,3,0,1] row_mask:0xf bank_mask:0xf
    s_nop 1
    v_max_f32_dpp v35, v34, v34 row_half_mirror row_mask:0xf bank_mask:0xf
    v_sub_f32 v32, v32, v35
    v_exp_f32 v32, v32
    s_nop 0
    v_mul_f32 v33, v33, v32
    s_nop 1
    v_add_f32_dpp v35, v33, v33 quad_perm:[1,0,3,2] row_mask:0xf bank_mask:0xf
    s_nop 1
    v_add_f32_dpp v33, v35, v35 quad_perm:[2,3,0,1] row_mask:0xf bank_mask:0xf
    s_nop 1
    v_add_f32_dpp v35, v33, v33 row_half_mirror row_mask:0xf bank_mask:0xf
    v_rcp_f32 v36, v35
    s_nop 0
    v_fma_f32 v37, -v36, v35, 1.0
    v_fma_f32 v36, v37, v36, v36
    s_waitcnt vmcnt(5)
    v_mul_f32 v28, v28, v32
    v_mul_f32 v29, v29, v32
    v_mul_f32 v30, v30, v32
    v_mul_f32 v31, v31, v32
    s_nop 1
    v_add_f32_dpp v38, v28, v28 quad_perm:[1,0,3,2] row_mask:0xf bank_mask:0xf
    s_nop 1
    v_add_f32_dpp v28, v38, v38 quad_perm:[2,3,0,1] row_mask:0xf bank_mask:0xf
    s_nop 1
    v_add_f32_dpp v38, v28, v28 row_half_mirror row_mask:0xf bank_mask:0xf
    v_mul_f32 v28, v38, v36
    v_cvt_pk_bf16_f32 v28, v28, v28
    v_and_b32 v28, 0xffff0000, v28
    s_nop 1
    v_add_f32_dpp v38, v29, v29 quad_perm:[1,0,3,2] row_mask:0xf bank_mask:0xf
    s_nop 1
    v_add_f32_dpp v29, v38, v38 quad_perm:[2,3,0,1] row_mask:0xf bank_mask:0xf
    s_nop 1
    v_add_f32_dpp v38, v29, v29 row_half_mirror row_mask:0xf bank_mask:0xf
    v_mul_f32 v29, v38, v36
    v_cvt_pk_bf16_f32 v29, v29, v29
    v_and_b32 v29, 0xffff0000, v29
    s_nop 1
    v_add_f32_dpp v38, v30, v30 quad_perm:[1,0,3,2] row_mask:0xf bank_mask:0xf
    s_nop 1
    v_add_f32_dpp v30, v38, v38 quad_perm:[2,3,0,1] row_mask:0xf bank_mask:0xf
    s_nop 1
    v_add_f32_dpp v38, v30, v30 row_half_mirror row_mask:0xf bank_mask:0xf
    v_mul_f32 v30, v38, v36
    v_cvt_pk_bf16_f32 v30, v30, v30
    v_and_b32 v30, 0xffff0000, v30
    s_nop 1
    v_add_f32_dpp v38, v31, v31 quad_perm:[1,0,3,2] row_mask:0xf bank_mask:0xf
    s_nop 1
    v_add_f32_dpp v31, v38, v38 quad_perm:[2,3,0,1] row_mask:0xf bank_mask:0xf
    s_nop 1
    v_add_f32_dpp v38, v31, v31 row_half_mirror row_mask:0xf bank_mask:0xf
    v_mul_f32 v31, v38, v36
    v_cvt_pk_bf16_f32 v31, v31, v31
    v_and_b32 v31, 0xffff0000, v31
    s_waitcnt vmcnt(0)
    s_branch O_go
O_w2:
    s_mov_b32 s40, s12
    s_mov_b32 s41, s13
    s_mov_b32 s42, 1966080
    s_mov_b32 s43, 0x00020000
    s_sub_u32 s61, s28, 6
    s_lshl_b32 s58, s2, 1
    s_add_u32 s61, s61, s58
    s_mul_i32 s56, s61, 5120
    s_lshl_b32 s59, s61, 4
    s_add_u32 s59, s59, 32768
    v_mov_b32 v6, 0
    buffer_load_dwordx4 v[40:43], v6, s[52:55], s59 offen
    s_add_u32 s59, s59, 6144
    buffer_load_dwordx4 v[44:47], v6, s[52:55], s59 offen
    s_add_u32 s59, s59, 6144
    buffer_load_dwordx4 v[48:51], v6, s[52:55], s59 offen
    s_add_u32 s59, s59, 6144
    buffer_load_dwordx4 v[52:55], v6, s[52:55], s59 offen
    s_add_u32 s59, s59, 6144
    s_mov_b32 s72, s18
    s_mov_b32 s73, s19
    s_mov_b32 s74, 3072
    s_mov_b32 s75, 0x00020000
    s_lshl_b32 s59, s61, 3
    buffer_load_dwordx2 v[56:57], v6, s[72:75], s59 offen
    s_add_u32 s62, s56, 4096
    buffer_load_dwordx4 v[8:11], v4, s[40:43], s56 offen offset:0 nt
    buffer_load_dwordx4 v[12:15], v4, s[40:43], s56 offen offset:1024 nt
    buffer_load_dwordx4 v[16:19], v4, s[40:43], s56 offen offset:2048 nt
    buffer_load_dwordx4 v[20:23], v4, s[40:43], s56 offen offset:3072 nt
    buffer_load_dwordx4 v[24:27], v4, s[40:43], s62 offen nt
    s_waitcnt vmcnt(5)
    v_add_f32 v28, v40, v44
    v_add_f32 v28, v28, v48
    v_add_f32 v28, v28, v52
    v_add_f32 v29, v41, v45
    v_add_f32 v29, v29, v49
    v_add_f32 v29, v29, v53
    v_add_f32 v30, v42, v46
    v_add_f32 v30, v30, v50
    v_add_f32 v30, v30, v54
    v_add_f32 v31, v43, v47
    v_add_f32 v31, v31, v51
    v_add_f32 v31, v31, v55
    v_lshlrev_b32 v32, 16, v56
    v_and_b32 v33, 0xffff0000, v56
    v_lshlrev_b32 v34, 16, v57
    v_and_b32 v35, 0xffff0000, v57
    v_cvt_pk_bf16_f32 v28, v28, v28
    v_and_b32 v28, 0xffff0000, v28
    v_add_f32 v28, v28, v32
    v_cvt_pk_bf16_f32 v28, v28, v28
    v_and_b32 v28, 0xffff0000, v28
    v_mul_f32 v36, v28, v28
    v_mul_f32 v36, v36, v28
    v_mov_b32 v37, 0x3d372713
    v_fma_f32 v36, v36, v37, v28
    v_mul_f32 v36, 0x40135761, v36
    v_exp_f32 v36, v36
    s_nop 0
    v_add_f32 v36, 1.0, v36
    v_rcp_f32 v36, v36
    s_nop 0
    v_fma_f32 v36, v36, -1.0, 1.0
    v_mul_f32 v28, v28, v36
    v_cvt_pk_bf16_f32 v28, v28, v28
    v_and_b32 v28, 0xffff0000, v28
    v_cvt_pk_bf16_f32 v29, v29, v29
    v_and_b32 v29, 0xffff0000, v29
    v_add_f32 v29, v29, v33
    v_cvt_pk_bf16_f32 v29, v29, v29
    v_and_b32 v29, 0xffff0000, v29
    v_mul_f32 v36, v29, v29
    v_mul_f32 v36, v36, v29
    v_mov_b32 v37, 0x3d372713
    v_fma_f32 v36, v36, v37, v29
    v_mul_f32 v36, 0x40135761, v36
    v_exp_f32 v36, v36
    s_nop 0
    v_add_f32 v36, 1.0, v36
    v_rcp_f32 v36, v36
    s_nop 0
    v_fma_f32 v36, v36, -1.0, 1.0
    v_mul_f32 v29, v29, v36
    v_cvt_pk_bf16_f32 v29, v29, v29
    v_and_b32 v29, 0xffff0000, v29
    v_cvt_pk_bf16_f32 v30, v30, v30
    v_and_b32 v30, 0xffff0000, v30
    v_add_f32 v30, v30, v34
    v_cvt_pk_bf16_f32 v30, v30, v30
    v_and_b32 v30, 0xffff0000, v30
    v_mul_f32 v36, v30, v30
    v_mul_f32 v36, v36, v30
    v_mov_b32 v37, 0x3d372713
    v_fma_f32 v36, v36, v37, v30
    v_mul_f32 v36, 0x40135761, v36
    v_exp_f32 v36, v36
    s_nop 0
    v_add_f32 v36, 1.0, v36
    v_rcp_f32 v36, v36
    s_nop 0
    v_fma_f32 v36, v36, -1.0, 1.0
    v_mul_f32 v30, v30, v36
    v_cvt_pk_bf16_f32 v30, v30, v30
    v_and_b32 v30, 0xffff0000, v30
    v_cvt_pk_bf16_f32 v31, v31, v31
    v_and_b32 v31, 0xffff0000, v31
    v_add_f32 v31, v31, v35
    v_cvt_pk_bf16_f32 v31, v31, v31
    v_and_b32 v31, 0xffff0000, v31
    v_mul_f32 v36, v31, v31
    v_mul_f32 v36, v36, v31
    v_mov_b32 v37, 0x3d372713
    v_fma_f32 v36, v36, v37, v31
    v_mul_f32 v36, 0x40135761, v36
    v_exp_f32 v36, v36
    s_nop 0
    v_add_f32 v36, 1.0, v36
    v_rcp_f32 v36, v36
    s_nop 0
    v_fma_f32 v36, v36, -1.0, 1.0
    v_mul_f32 v31, v31, v36
    v_cvt_pk_bf16_f32 v31, v31, v31
    v_and_b32 v31, 0xffff0000, v31
    s_waitcnt vmcnt(0)
O_go:
    v_cndmask_b32 v32, v29, v28, s[64:65]
    v_cndmask_b32 v33, v30, v29, s[66:67]
    v_cndmask_b32 v34, v31, v30, s[68:69]
    v_lshlrev_b32 v36, 16, v8
    v_and_b32 v37, 0xffff0000, v8
    v_pk_mul_f32 v[40:41], v[36:37], v[28:29] op_sel_hi:[1,0]
    v_lshlrev_b32 v38, 16, v9
    v_and_b32 v39, 0xffff0000, v9
    v_pk_mul_f32 v[42:43], v[38:39], v[28:29] op_sel_hi:[1,0]
    v_lshlrev_b32 v36, 16, v10
    v_and_b32 v37, 0xffff0000, v10
    v_pk_mul_f32 v[44:45], v[36:37], v[28:29] op_sel_hi:[1,0]
    v_lshlrev_b32 v38, 16, v11
    v_and_b32 v39, 0xffff0000, v11
    v_pk_mul_f32 v[46:47], v[38:39], v[28:29] op_sel_hi:[1,0]
    v_lshlrev_b32 v36, 16, v12
    v_and_b32 v37, 0xffff0000, v12
    v_pk_mul_f32 v[48:49], v[36:37], v[32:33] op_sel_hi:[1,0]
    v_lshlrev_b32 v38, 16, v13
    v_and_b32 v39, 0xffff0000, v13
    v_pk_mul_f32 v[50:51], v[38:39], v[32:33] op_sel_hi:[1,0]
    v_lshlrev_b32 v36, 16, v14
    v_and_b32 v37, 0xffff0000, v14
    v_pk_mul_f32 v[52:53], v[36:37], v[32:33] op_sel_hi:[1,0]
    v_lshlrev_b32 v38, 16, v15
    v_and_b32 v39, 0xffff0000, v15
    v_pk_mul_f32 v[54:55], v[38:39], v[32:33] op_sel_hi:[1,0]
    v_lshlrev_b32 v36, 16, v16
    v_and_b32 v37, 0xffff0000, v16
    v_pk_mul_f32 v[56:57], v[36:37], v[32:33] op_sel:[0,1] op_sel_hi:[1,1]
    v_lshlrev_b32 v38, 16, v17
    v_and_b32 v39, 0xffff0000, v17
    v_pk_mul_f32 v[58:59], v[38:39], v[32:33] op_sel:[0,1] op_sel_hi:[1,1]
    v_lshlrev_b32 v36, 16, v18
    v_and_b32 v37, 0xffff0000, v18
    v_pk_mul_f32 v[60:61], v[36:37], v[32:33] op_sel:[0,1] op_sel_hi:[1,1]
    v_lshlrev_b32 v38, 16, v19
    v_and_b32 v39, 0xffff0000, v19
    v_pk_mul_f32 v[62:63], v[38:39], v[32:33] op_sel:[0,1] op_sel_hi:[1,1]
    v_lshlrev_b32 v36, 16, v20
    v_and_b32 v37, 0xffff0000, v20
    v_pk_mul_f32 v[64:65], v[36:37], v[34:35] op_sel_hi:[1,0]
    v_lshlrev_b32 v38, 16, v21
    v_and_b32 v39, 0xffff0000, v21
    v_pk_mul_f32 v[66:67], v[38:39], v[34:35] op_sel_hi:[1,0]
    v_lshlrev_b32 v36, 16, v22
    v_and_b32 v37, 0xffff0000, v22
    v_pk_mul_f32 v[68:69], v[36:37], v[34:35] op_sel_hi:[1,0]
    v_lshlrev_b32 v38, 16, v23
    v_and_b32 v39, 0xffff0000, v23
    v_pk_mul_f32 v[70:71], v[38:39], v[34:35] op_sel_hi:[1,0]
    v_lshlrev_b32 v36, 16, v24
    v_and_b32 v37, 0xffff0000, v24
    v_pk_mul_f32 v[72:73], v[36:37], v[30:31] op_sel:[0,1] op_sel_hi:[1,1]
    v_lshlrev_b32 v38, 16, v25
    v_and_b32 v39, 0xffff0000, v25
    v_pk_mul_f32 v[74:75], v[38:39], v[30:31] op_sel:[0,1] op_sel_hi:[1,1]
    v_lshlrev_b32 v36, 16, v26
    v_and_b32 v37, 0xffff0000, v26
    v_pk_mul_f32 v[76:77], v[36:37], v[30:31] op_sel:[0,1] op_sel_hi:[1,1]
    v_lshlrev_b32 v38, 16, v27
    v_and_b32 v39, 0xffff0000, v27
    v_pk_mul_f32 v[78:79], v[38:39], v[30:31] op_sel:[0,1] op_sel_hi:[1,1]
    s_mul_i32 s58, s28, 10240
    v_lshlrev_b32 v7, 5, v1
    v_add_u32 v7, s58, v7
    ds_write_b128 v7, v[40:43] offset:0
    ds_write_b128 v7, v[44:47] offset:16
    ds_write_b128 v7, v[48:51] offset:2048
    ds_write_b128 v7, v[52:55] offset:2064
    ds_write_b128 v7, v[56:59] offset:4096
    ds_write_b128 v7, v[60:63] offset:4112
    ds_write_b128 v7, v[64:67] offset:6144
    ds_write_b128 v7, v[68:71] offset:6160
    ds_write_b128 v7, v[72:75] offset:8192
    ds_write_b128 v7, v[76:79] offset:8208
    s_waitcnt lgkmcnt(0)
    s_barrier
    v_and_b32 v6, 0xff, v0
    v_cmp_gt_u32 vcc, 160, v6
    s_and_saveexec_b64 s[70:71], vcc
    s_cbranch_execz O_done
    v_lshlrev_b32 v7, 4, v6
    s_cmp_ge_u32 s28, 4
    s_cbranch_scc1 O_y
    ds_read_b128 v[8:11], v7 offset:0
    ds_read_b128 v[12:15], v7 offset:2560
    ds_read_b128 v[16:19], v7 offset:5120
    ds_read_b128 v[20:23], v7 offset:7680
    ds_read_b128 v[24:27], v7 offset:10240
    ds_read_b128 v[28:31], v7 offset:12800
    ds_read_b128 v[32:35], v7 offset:15360
    ds_read_b128 v[36:39], v7 offset:17920
    ds_read_b128 v[40:43], v7 offset:20480
    ds_read_b128 v[44:47], v7 offset:23040
    ds_read_b128 v[48:51], v7 offset:25600
    ds_read_b128 v[52:55], v7 offset:28160
    ds_read_b128 v[56:59], v7 offset:30720
    ds_read_b128 v[60:63], v7 offset:33280
    ds_read_b128 v[64:67], v7 offset:35840
    ds_read_b128 v[68:71], v7 offset:38400
    ds_read_b128 v[72:75], v7 offset:40960
    ds_read_b128 v[76:79], v7 offset:43520
    ds_read_b128 v[80:83], v7 offset:46080
    ds_read_b128 v[84:87], v7 offset:48640
    ds_read_b128 v[88:91], v7 offset:51200
    ds_read_b128 v[92:95], v7 offset:53760
    ds_read_b128 v[96:99], v7 offset:56320
    ds_read_b128 v[100:103], v7 offset:58880
    s_waitcnt lgkmcnt(15)
    v_pk_add_f32 v[8:9], v[8:9], v[12:13]
    v_pk_add_f32 v[10:11], v[10:11], v[14:15]
    s_waitcnt lgkmcnt(15)
    v_pk_add_f32 v[8:9], v[8:9], v[16:17]
    v_pk_add_f32 v[10:11], v[10:11], v[18:19]
    s_waitcnt lgkmcnt(15)
    v_pk_add_f32 v[8:9], v[8:9], v[20:21]
    v_pk_add_f32 v[10:11], v[10:11], v[22:23]
    s_waitcnt lgkmcnt(15)
    v_pk_add_f32 v[8:9], v[8:9], v[24:25]
    v_pk_add_f32 v[10:11], v[10:11], v[26:27]
    s_waitcnt lgkmcnt(15)
    v_pk_add_f32 v[8:9], v[8:9], v[28:29]
    v_pk_add_f32 v[10:11], v[10:11], v[30:31]
    s_waitcnt lgkmcnt(15)
    v_pk_add_f32 v[8:9], v[8:9], v[32:33]
    v_pk_add_f32 v[10:11], v[10:11], v[34:35]
    s_waitcnt lgkmcnt(15)
    v_pk_add_f32 v[8:9], v[8:9], v[36:37]
    v_pk_add_f32 v[10:11], v[10:11], v[38:39]
    s_waitcnt lgkmcnt(15)
    v_pk_add_f32 v[8:9], v[8:9], v[40:41]
    v_pk_add_f32 v[10:11], v[10:11], v[42:43]
    s_waitcnt lgkmcnt(14)
    v_pk_add_f32 v[8:9], v[8:9], v[44:45]
    v_pk_add_f32 v[10:11], v[10:11], v[46:47]
    s_waitcnt lgkmcnt(13)
    v_pk_add_f32 v[8:9], v[8:9], v[48:49]
    v_pk_add_f32 v[10:11], v[10:11], v[50:51]
    s_waitcnt lgkmcnt(12)
    v_pk_add_f32 v[8:9], v[8:9], v[52:53]
    v_pk_add_f32 v[10:11], v[10:11], v[54:55]
    s_waitcnt lgkmcnt(11)
    v_pk_add_f32 v[8:9], v[8:9], v[56:57]
    v_pk_add_f32 v[10:11], v[10:11], v[58:59]
    s_waitcnt lgkmcnt(10)
    v_pk_add_f32 v[8:9], v[8:9], v[60:61]
    v_pk_add_f32 v[10:11], v[10:11], v[62:63]
    s_waitcnt lgkmcnt(9)
    v_pk_add_f32 v[8:9], v[8:9], v[64:65]
    v_pk_add_f32 v[10:11], v[10:11], v[66:67]
    s_waitcnt lgkmcnt(8)
    v_pk_add_f32 v[8:9], v[8:9], v[68:69]
    v_pk_add_f32 v[10:11], v[10:11], v[70:71]
    s_waitcnt lgkmcnt(7)
    v_pk_add_f32 v[8:9], v[8:9], v[72:73]
    v_pk_add_f32 v[10:11], v[10:11], v[74:75]
    s_waitcnt lgkmcnt(6)
    v_pk_add_f32 v[8:9], v[8:9], v[76:77]
    v_pk_add_f32 v[10:11], v[10:11], v[78:79]
    s_waitcnt lgkmcnt(5)
    v_pk_add_f32 v[8:9], v[8:9], v[80:81]
    v_pk_add_f32 v[10:11], v[10:11], v[82:83]
    s_waitcnt lgkmcnt(4)
    v_pk_add_f32 v[8:9], v[8:9], v[84:85]
    v_pk_add_f32 v[10:11], v[10:11], v[86:87]
    s_waitcnt lgkmcnt(3)
    v_pk_add_f32 v[8:9], v[8:9], v[88:89]
    v_pk_add_f32 v[10:11], v[10:11], v[90:91]
    s_waitcnt lgkmcnt(2)
    v_pk_add_f32 v[8:9], v[8:9], v[92:93]
    v_pk_add_f32 v[10:11], v[10:11], v[94:95]
    s_waitcnt lgkmcnt(1)
    v_pk_add_f32 v[8:9], v[8:9], v[96:97]
    v_pk_add_f32 v[10:11], v[10:11], v[98:99]
    s_waitcnt lgkmcnt(0)
    v_pk_add_f32 v[8:9], v[8:9], v[100:101]
    v_pk_add_f32 v[10:11], v[10:11], v[102:103]
    s_mul_i32 s58, s2, 2560
    s_add_u32 s58, s58, 393216
    buffer_store_dwordx4 v[8:11], v7, s[52:55], s58 offen
    s_endpgm
O_y:
    s_cmp_ge_u32 s2, 192
    s_cbranch_scc1 O_done
    v_add_u32 v6, 61440, v7
    ds_read_b128 v[8:11], v6 offset:0
    ds_read_b128 v[12:15], v6 offset:2560
    ds_read_b128 v[16:19], v6 offset:5120
    ds_read_b128 v[20:23], v6 offset:7680
    ds_read_b128 v[24:27], v6 offset:10240
    ds_read_b128 v[28:31], v6 offset:12800
    ds_read_b128 v[32:35], v6 offset:15360
    ds_read_b128 v[36:39], v6 offset:17920
    s_waitcnt lgkmcnt(6)
    v_pk_add_f32 v[8:9], v[8:9], v[12:13]
    v_pk_add_f32 v[10:11], v[10:11], v[14:15]
    s_waitcnt lgkmcnt(5)
    v_pk_add_f32 v[8:9], v[8:9], v[16:17]
    v_pk_add_f32 v[10:11], v[10:11], v[18:19]
    s_waitcnt lgkmcnt(4)
    v_pk_add_f32 v[8:9], v[8:9], v[20:21]
    v_pk_add_f32 v[10:11], v[10:11], v[22:23]
    s_waitcnt lgkmcnt(3)
    v_pk_add_f32 v[8:9], v[8:9], v[24:25]
    v_pk_add_f32 v[10:11], v[10:11], v[26:27]
    s_waitcnt lgkmcnt(2)
    v_pk_add_f32 v[8:9], v[8:9], v[28:29]
    v_pk_add_f32 v[10:11], v[10:11], v[30:31]
    s_waitcnt lgkmcnt(1)
    v_pk_add_f32 v[8:9], v[8:9], v[32:33]
    v_pk_add_f32 v[10:11], v[10:11], v[34:35]
    s_waitcnt lgkmcnt(0)
    v_pk_add_f32 v[8:9], v[8:9], v[36:37]
    v_pk_add_f32 v[10:11], v[10:11], v[38:39]
    s_mul_i32 s58, s2, 2560
    s_add_u32 s58, s58, 1048576
    buffer_store_dwordx4 v[8:11], v7, s[52:55], s58 offen
O_done:
    s_endpgm
.globl final_kernel
.p2align 8
.type final_kernel,@function
final_kernel:
    s_cmp_ge_u32 s2, 20
    s_cbranch_scc1 B_done
    s_load_dwordx2 s[4:5], s[0:1], 0
    s_load_dwordx2 s[20:21], s[0:1], 72
    s_load_dwordx2 s[22:23], s[0:1], 80
    s_load_dwordx2 s[26:27], s[0:1], 96
    v_lshrrev_b32 v1, 3, v0
    v_and_b32 v2, 7, v0
    v_lshlrev_b32 v2, 4, v2
    v_mul_u32_u24 v3, 20480, v1
    v_add_u32 v3, v3, v2
    v_mul_u32_u24 v5, 15360, v1
    v_add_u32 v5, v5, v2
    s_lshl_b32 s30, s2, 7
    s_add_u32 s30, s30, 393216
    s_waitcnt lgkmcnt(0)
    s_mov_b32 s52, s26
    s_mov_b32 s53, s27
    s_mov_b32 s54, 1540096
    s_mov_b32 s55, 0x00020000
    s_mov_b32 s48, s4
    s_mov_b32 s49, s5
    s_mov_b32 s50, 1280
    s_mov_b32 s51, 0x00020000
    s_mov_b32 s72, s20
    s_mov_b32 s73, s21
    s_mov_b32 s74, 1280
    s_mov_b32 s75, 0x00020000
    s_mov_b32 s32, s22
    s_mov_b32 s33, s23
    s_mov_b32 s34, 1280
    s_mov_b32 s35, 0x00020000
    s_add_u32 s29, s30, 0
    buffer_load_dwordx4 v[24:27], v3, s[52:55], s29 offen offset:0
    buffer_load_dwordx4 v[28:31], v3, s[52:55], s29 offen offset:2560
    s_add_u32 s29, s30, 5120
    buffer_load_dwordx4 v[32:35], v3, s[52:55], s29 offen offset:0
    buffer_load_dwordx4 v[36:39], v3, s[52:55], s29 offen offset:2560
    s_add_u32 s29, s30, 10240
    buffer_load_dwordx4 v[40:43], v3, s[52:55], s29 offen offset:0
    buffer_load_dwordx4 v[44:47], v3, s[52:55], s29 offen offset:2560
    s_add_u32 s29, s30, 15360
    buffer_load_dwordx4 v[48:51], v3, s[52:55], s29 offen offset:0
    buffer_load_dwordx4 v[52:55], v3, s[52:55], s29 offen offset:2560
    s_add_u32 s28, s30, 655360
    buffer_load_dwordx4 v[80:83], v5, s[52:55], s28 offen offset:0
    buffer_load_dwordx4 v[84:87], v5, s[52:55], s28 offen offset:2560
    s_add_u32 s28, s30, 660480
    buffer_load_dwordx4 v[88:91], v5, s[52:55], s28 offen offset:0
    buffer_load_dwordx4 v[92:95], v5, s[52:55], s28 offen offset:2560
    s_add_u32 s28, s30, 665600
    buffer_load_dwordx4 v[96:99], v5, s[52:55], s28 offen offset:0
    buffer_load_dwordx4 v[100:103], v5, s[52:55], s28 offen offset:2560
    v_lshrrev_b32 v6, 1, v2
    s_lshl_b32 s27, s2, 6
    buffer_load_dwordx2 v[64:65], v6, s[48:51], s27 offen
    buffer_load_dwordx2 v[66:67], v6, s[72:75], s27 offen
    s_waitcnt vmcnt(8)
    v_add_f32 v68, v24, v28
    v_add_f32 v69, v25, v29
    v_add_f32 v70, v26, v30
    v_add_f32 v71, v27, v31
    v_add_f32 v68, v68, v32
    v_add_f32 v69, v69, v33
    v_add_f32 v70, v70, v34
    v_add_f32 v71, v71, v35
    v_add_f32 v68, v68, v36
    v_add_f32 v69, v69, v37
    v_add_f32 v70, v70, v38
    v_add_f32 v71, v71, v39
    v_add_f32 v68, v68, v40
    v_add_f32 v69, v69, v41
    v_add_f32 v70, v70, v42
    v_add_f32 v71, v71, v43
    v_add_f32 v68, v68, v44
    v_add_f32 v69, v69, v45
    v_add_f32 v70, v70, v46
    v_add_f32 v71, v71, v47
    v_add_f32 v68, v68, v48
    v_add_f32 v69, v69, v49
    v_add_f32 v70, v70, v50
    v_add_f32 v71, v71, v51
    v_add_f32 v68, v68, v52
    v_add_f32 v69, v69, v53
    v_add_f32 v70, v70, v54
    v_add_f32 v71, v71, v55
    s_waitcnt vmcnt(2)
    v_add_f32 v72, v80, v84
    v_add_f32 v73, v81, v85
    v_add_f32 v74, v82, v86
    v_add_f32 v75, v83, v87
    v_add_f32 v72, v72, v88
    v_add_f32 v73, v73, v89
    v_add_f32 v74, v74, v90
    v_add_f32 v75, v75, v91
    v_add_f32 v72, v72, v92
    v_add_f32 v73, v73, v93
    v_add_f32 v74, v74, v94
    v_add_f32 v75, v75, v95
    v_add_f32 v72, v72, v96
    v_add_f32 v73, v73, v97
    v_add_f32 v74, v74, v98
    v_add_f32 v75, v75, v99
    v_add_f32 v72, v72, v100
    v_add_f32 v73, v73, v101
    v_add_f32 v74, v74, v102
    v_add_f32 v75, v75, v103
    s_nop 1
    v_permlane32_swap_b32 v68, v72
    v_permlane32_swap_b32 v69, v73
    v_permlane32_swap_b32 v70, v74
    v_permlane32_swap_b32 v71, v75
    v_add_f32 v68, v68, v72
    v_add_f32 v69, v69, v73
    v_add_f32 v70, v70, v74
    v_add_f32 v71, v71, v75
    s_nop 1
    v_permlane16_swap_b32 v68, v70
    v_permlane16_swap_b32 v69, v71
    v_add_f32 v68, v68, v70
    v_add_f32 v69, v69, v71
    s_nop 1
    v_add_f32_dpp v70, v68, v68 row_ror:8 row_mask:0xf bank_mask:0xf
    v_add_f32_dpp v71, v69, v69 row_ror:8 row_mask:0xf bank_mask:0xf
    v_and_b32 v6, 63, v0
    v_lshrrev_b32 v7, 4, v6
    v_lshlrev_b32 v7, 3, v7
    v_and_b32 v6, 7, v0
    v_lshl_add_u32 v7, v6, 5, v7
    v_lshrrev_b32 v6, 6, v0
    v_lshl_add_u32 v7, v6, 8, v7
    ds_write_b64 v7, v[70:71]
    s_waitcnt lgkmcnt(0)
    s_barrier
    v_cmp_gt_u32 vcc, 8, v0
    s_and_saveexec_b64 s[70:71], vcc
    s_cbranch_execz B_done
    v_lshlrev_b32 v7, 5, v0
    ds_read_b128 v[8:11], v7 offset:0
    ds_read_b128 v[12:15], v7 offset:16
    ds_read_b128 v[16:19], v7 offset:256
    ds_read_b128 v[20:23], v7 offset:272
    ds_read_b128 v[24:27], v7 offset:512
    ds_read_b128 v[28:31], v7 offset:528
    ds_read_b128 v[32:35], v7 offset:768
    ds_read_b128 v[36:39], v7 offset:784
    s_waitcnt lgkmcnt(0)
    v_add_f32 v8, v8, v16
    v_add_f32 v9, v9, v17
    v_add_f32 v10, v10, v18
    v_add_f32 v11, v11, v19
    v_add_f32 v12, v12, v20
    v_add_f32 v13, v13, v21
    v_add_f32 v14, v14, v22
    v_add_f32 v15, v15, v23
    v_add_f32 v8, v8, v24
    v_add_f32 v9, v9, v25
    v_add_f32 v10, v10, v26
    v_add_f32 v11, v11, v27
    v_add_f32 v12, v12, v28
    v_add_f32 v13, v13, v29
    v_add_f32 v14, v14, v30
    v_add_f32 v15, v15, v31
    v_add_f32 v8, v8, v32
    v_add_f32 v9, v9, v33
    v_add_f32 v10, v10, v34
    v_add_f32 v11, v11, v35
    v_add_f32 v12, v12, v36
    v_add_f32 v13, v13, v37
    v_add_f32 v14, v14, v38
    v_add_f32 v15, v15, v39
    s_waitcnt vmcnt(0)
    v_lshlrev_b32 v16, 16, v64
    v_and_b32 v17, 0xffff0000, v64
    v_lshlrev_b32 v18, 16, v65
    v_and_b32 v19, 0xffff0000, v65
    v_lshlrev_b32 v20, 16, v66
    v_and_b32 v21, 0xffff0000, v66
    v_lshlrev_b32 v22, 16, v67
    v_and_b32 v23, 0xffff0000, v67
    v_cvt_pk_bf16_f32 v8, v8, v8
    v_and_b32 v8, 0xffff0000, v8
    v_cvt_pk_bf16_f32 v12, v12, v12
    v_and_b32 v12, 0xffff0000, v12
    v_add_f32 v12, v12, v20
    v_cvt_pk_bf16_f32 v12, v12, v12
    v_and_b32 v12, 0xffff0000, v12
    v_mul_f32 v24, 0xbfb8aa3b, v12
    v_exp_f32 v24, v24
    s_nop 0
    v_add_f32 v24, 1.0, v24
    v_rcp_f32 v25, v24
    s_nop 0
    v_mul_f32 v26, v12, v25
    v_fma_f32 v27, -v26, v24, v12
    v_fma_f32 v12, v27, v25, v26
    v_cvt_pk_bf16_f32 v12, v12, v12
    v_and_b32 v12, 0xffff0000, v12
    v_mul_f32 v8, v8, v12
    v_cvt_pk_bf16_f32 v8, v8, v8
    v_and_b32 v8, 0xffff0000, v8
    v_add_f32 v8, v8, v16
    v_cvt_pk_bf16_f32 v9, v9, v9
    v_and_b32 v9, 0xffff0000, v9
    v_cvt_pk_bf16_f32 v13, v13, v13
    v_and_b32 v13, 0xffff0000, v13
    v_add_f32 v13, v13, v21
    v_cvt_pk_bf16_f32 v13, v13, v13
    v_and_b32 v13, 0xffff0000, v13
    v_mul_f32 v24, 0xbfb8aa3b, v13
    v_exp_f32 v24, v24
    s_nop 0
    v_add_f32 v24, 1.0, v24
    v_rcp_f32 v25, v24
    s_nop 0
    v_mul_f32 v26, v13, v25
    v_fma_f32 v27, -v26, v24, v13
    v_fma_f32 v13, v27, v25, v26
    v_cvt_pk_bf16_f32 v13, v13, v13
    v_and_b32 v13, 0xffff0000, v13
    v_mul_f32 v9, v9, v13
    v_cvt_pk_bf16_f32 v9, v9, v9
    v_and_b32 v9, 0xffff0000, v9
    v_add_f32 v9, v9, v17
    v_cvt_pk_bf16_f32 v10, v10, v10
    v_and_b32 v10, 0xffff0000, v10
    v_cvt_pk_bf16_f32 v14, v14, v14
    v_and_b32 v14, 0xffff0000, v14
    v_add_f32 v14, v14, v22
    v_cvt_pk_bf16_f32 v14, v14, v14
    v_and_b32 v14, 0xffff0000, v14
    v_mul_f32 v24, 0xbfb8aa3b, v14
    v_exp_f32 v24, v24
    s_nop 0
    v_add_f32 v24, 1.0, v24
    v_rcp_f32 v25, v24
    s_nop 0
    v_mul_f32 v26, v14, v25
    v_fma_f32 v27, -v26, v24, v14
    v_fma_f32 v14, v27, v25, v26
    v_cvt_pk_bf16_f32 v14, v14, v14
    v_and_b32 v14, 0xffff0000, v14
    v_mul_f32 v10, v10, v14
    v_cvt_pk_bf16_f32 v10, v10, v10
    v_and_b32 v10, 0xffff0000, v10
    v_add_f32 v10, v10, v18
    v_cvt_pk_bf16_f32 v11, v11, v11
    v_and_b32 v11, 0xffff0000, v11
    v_cvt_pk_bf16_f32 v15, v15, v15
    v_and_b32 v15, 0xffff0000, v15
    v_add_f32 v15, v15, v23
    v_cvt_pk_bf16_f32 v15, v15, v15
    v_and_b32 v15, 0xffff0000, v15
    v_mul_f32 v24, 0xbfb8aa3b, v15
    v_exp_f32 v24, v24
    s_nop 0
    v_add_f32 v24, 1.0, v24
    v_rcp_f32 v25, v24
    s_nop 0
    v_mul_f32 v26, v15, v25
    v_fma_f32 v27, -v26, v24, v15
    v_fma_f32 v15, v27, v25, v26
    v_cvt_pk_bf16_f32 v15, v15, v15
    v_and_b32 v15, 0xffff0000, v15
    v_mul_f32 v11, v11, v15
    v_cvt_pk_bf16_f32 v11, v11, v11
    v_and_b32 v11, 0xffff0000, v11
    v_add_f32 v11, v11, v19
    v_cvt_pk_bf16_f32 v28, v8, v9
    v_cvt_pk_bf16_f32 v29, v10, v11
    v_lshlrev_b32 v6, 3, v0
    buffer_store_dwordx2 v[28:29], v6, s[32:35], s27 offen
B_done:
    s_endpgm
.section .rodata,"a"
.p2align 6
.amdhsa_kernel proj_kernel
  .amdhsa_next_free_vgpr 80
  .amdhsa_next_free_sgpr 102
  .amdhsa_accum_offset 80
  .amdhsa_group_segment_fixed_size 0
  .amdhsa_kernarg_size 104
  .amdhsa_user_sgpr_count 2
  .amdhsa_user_sgpr_kernarg_segment_ptr 1
  .amdhsa_system_sgpr_workgroup_id_x 1
.end_amdhsa_kernel
.p2align 6
.amdhsa_kernel attn_kernel
  .amdhsa_next_free_vgpr 112
  .amdhsa_next_free_sgpr 102
  .amdhsa_accum_offset 112
  .amdhsa_group_segment_fixed_size 0
  .amdhsa_kernarg_size 104
  .amdhsa_user_sgpr_count 2
  .amdhsa_user_sgpr_kernarg_segment_ptr 1
  .amdhsa_system_sgpr_workgroup_id_x 1
.end_amdhsa_kernel
.p2align 6
.amdhsa_kernel oproj_kernel
  .amdhsa_next_free_vgpr 104
  .amdhsa_next_free_sgpr 102
  .amdhsa_accum_offset 104
  .amdhsa_group_segment_fixed_size 0
  .amdhsa_kernarg_size 104
  .amdhsa_user_sgpr_count 2
  .amdhsa_user_sgpr_kernarg_segment_ptr 1
  .amdhsa_system_sgpr_workgroup_id_x 1
.end_amdhsa_kernel
.p2align 6
.amdhsa_kernel final_kernel
  .amdhsa_next_free_vgpr 104
  .amdhsa_next_free_sgpr 102
  .amdhsa_accum_offset 104
  .amdhsa_group_segment_fixed_size 0
  .amdhsa_kernarg_size 104
  .amdhsa_user_sgpr_count 2
  .amdhsa_user_sgpr_kernarg_segment_ptr 1
  .amdhsa_system_sgpr_workgroup_id_x 1
.end_amdhsa_kernel
```
